```python
import torch

def _softmax(x, axis=-1):
    return torch.softmax(x, dim=axis)
def _gelu(x):
    return torch.nn.functional.gelu(x, approximate="tanh")
def _silu(x):
    return torch.nn.functional.silu(x)
def _sigmoid(x):
    return torch.sigmoid(x)
def _layernorm(x, axis=-1, eps=1e-5):
    m = x.mean(dim=axis, keepdim=True)
    v = x.var(dim=axis, keepdim=True, unbiased=False)
    return (x - m) / torch.sqrt(v + eps)
def _scatter_add(tgt, idx, src, axis=0):
    return tgt.clone().index_add_(axis, idx, src)
def _segment_sum(src, seg, n):
    out = torch.zeros((n,) + src.shape[1:], dtype=src.dtype)
    return out.index_add_(0, seg, src)
def _pad(x, pw):
    flat = tuple(v for pair in reversed(pw) for v in pair)
    return torch.nn.functional.pad(x, flat)

kernel_name = 'recurrent_scan__gqa_block_cached__glu_gated_geglu__decode'

def setup_inputs():

    _w = (lambda a: (lambda t: t.to(torch.bfloat16) if t.is_floating_point() else t)(torch.as_tensor(a)))
    def _A_setup():
        B, Sq, D = 4, 1, 1024
        Hq, Hkv, Sk, Dh = 32, 4, 8192, 128
        assert Hq % Hkv == 0, (Hq, Hkv)
        return {
            "x": _w((lambda *s: torch.randn(*s, dtype=torch.bfloat16) * 0.4)(B, Sq, D)),
            "k_cache": _w((lambda *s: torch.randn(*s, dtype=torch.bfloat16) * 1.6)(B, Hkv, Sk, Dh)),
            "v_cache": _w((lambda *s: torch.randn(*s, dtype=torch.bfloat16) * 1.6)(B, Hkv, Sk, Dh)),
            "wq": _w((lambda *s: torch.randn(*s, dtype=torch.bfloat16) * 1.6)(D, Hq * Dh) * (D ** -0.5)),
            "wo": _w((lambda *s: torch.randn(*s, dtype=torch.bfloat16) * 1.6)(Hq * Dh, D) * ((Hq * Dh) ** -0.5)),
        }
    _A_in = _A_setup()

    def _B_setup():
        B, S, Dm, Df = 4, 1, 1024, 3584
        return {
            "x": _w((lambda *s: torch.randn(*s, dtype=torch.bfloat16) * 0.4)(B, S, Dm)),
            "w_gate": _w((lambda *s: torch.randn(*s, dtype=torch.bfloat16) * 1.6)(Dm, Df) * (Dm ** -0.5)),
            "w_up": _w((lambda *s: torch.randn(*s, dtype=torch.bfloat16) * 1.6)(Dm, Df) * (Dm ** -0.5)),
            "w_down": _w((lambda *s: torch.randn(*s, dtype=torch.bfloat16) * 1.6)(Df, Dm) * (Df ** -0.5)),
        }
    _B_in = _B_setup()

    return {
        "A_x": _A_in["x"],
        "A_k_cache": _A_in["k_cache"],
        "A_v_cache": _A_in["v_cache"],
        "A_wq": _A_in["wq"],
        "A_wo": _A_in["wo"],
        "B_x": _B_in["x"],
        "B_w_gate": _B_in["w_gate"],
        "B_w_up": _B_in["w_up"],
        "B_w_down": _B_in["w_down"],
    }

def reference(A_x, A_k_cache, A_v_cache, A_wq, A_wo, B_x, B_w_gate, B_w_up, B_w_down):
    def _A_ref(x, k_cache, v_cache, wq, wo):
        B, Sq, D = x.shape
        Hq, Dh = 32, 128
        Hkv = k_cache.shape[1]
        rep = Hq // Hkv
        q = (lambda x, *d: x.permute(*d))((x @ wq).reshape(B, Sq, Hq, Dh), 0, 2, 1, 3)
        k = (lambda x, n, axis: torch.repeat_interleave(x, n, dim=axis))(k_cache, rep, axis=1)
        v = (lambda x, n, axis: torch.repeat_interleave(x, n, dim=axis))(v_cache, rep, axis=1)
        scores = torch.einsum("bhqd,bhkd->bhqk", q, k) * (Dh ** -0.5)
        p = _softmax(scores, axis=-1)
        o = torch.einsum("bhqk,bhkd->bhqd", p, v)
        return (lambda x, *d: x.permute(*d))(o, 0, 2, 1, 3).reshape(B, Sq, Hq * Dh) @ wo

    def _B_ref(x, w_gate, w_up, w_down):
        g = torch.einsum("bsd,df->bsf", x, w_gate)
        u = torch.einsum("bsd,df->bsf", x, w_up)
        h = _gelu(g) * u
        return torch.einsum("bsf,fd->bsd", h, w_down)

    x = A_x
    xn = _layernorm(x, axis=-1)
    s = _A_ref(xn, A_k_cache, A_v_cache, A_wq, A_wo)
    g = _silu(_B_ref(xn, B_w_gate, B_w_up, B_w_down))
    return x + s * g
```

```asm
; @launch grid=(256,1,1) block=(768,1,1) lds=139264
.amdgcn_target "amdgcn-amd-amdhsa--gfx950"
.text
.globl recurrent_scan__gqa_block_cached__glu_gated_geglu__decode_kernel
.p2align 8
.type recurrent_scan__gqa_block_cached__glu_gated_geglu__decode_kernel,@function
recurrent_scan__gqa_block_cached__glu_gated_geglu__decode_kernel:
    s_cmp_ge_u32 s2, 256
    s_cbranch_scc1 L_end
    s_load_dwordx16 s[16:31], s[0:1], 0
    s_load_dwordx8 s[32:39], s[0:1], 64
    v_lshrrev_b32 v1, 6, v0
    v_and_b32 v0, 63, v0
    s_nop 0
    v_readfirstlane_b32 s3, v1
    s_and_b32 s4, s2, 7
    s_lshr_b32 s5, s2, 3
    s_lshl_b32 s96, s4, 5
    s_add_u32 s96, s96, s5
    s_mul_i32 s97, s4, 28
    s_add_u32 s97, s97, s5
    s_mov_b32 s68, 0x05040100
    s_mov_b32 s69, 0x07060302
    s_mov_b32 s70, 0x3db504f3
    s_mov_b32 s71, 0x3fb8aa3b
    s_mov_b32 s42, 0xff
    s_mov_b32 s89, 0xfff
    s_mov_b32 s43, 0x0c0c0400
    s_mov_b32 s88, 0x04000c0c
    s_waitcnt lgkmcnt(0)
    s_load_dword s40, s[38:39], 0
    s_mov_b32 s44, s18
    s_mov_b32 s45, s19
    s_mov_b32 s46, 33554432
    s_mov_b32 s47, 0x00020000
    s_mov_b32 s48, s20
    s_mov_b32 s49, s21
    s_mov_b32 s50, 33554432
    s_mov_b32 s51, 0x00020000
    s_mov_b32 s56, s38
    s_mov_b32 s57, s39
    s_mov_b32 s58, 268435456
    s_mov_b32 s59, 0x00020000
    s_mov_b32 s60, s16
    s_mov_b32 s61, s17
    s_mov_b32 s62, 8192
    s_mov_b32 s63, 0x00020000
    s_mov_b32 s64, s34
    s_mov_b32 s65, s35
    s_mov_b32 s66, 8192
    s_mov_b32 s67, 0x00020000
    s_cmp_ge_u32 s3, 8
    s_cbranch_scc1 L_notattn
    s_lshl_b32 s6, s96, 17
    s_lshl_b32 s5, s3, 14
    s_add_u32 s6, s6, s5
    v_and_b32 v2, 15, v0
    v_lshrrev_b32 v3, 4, v0
    v_lshlrev_b32 v4, 8, v2
    v_lshl_add_u32 v4, v3, 4, v4
    v_lshlrev_b32 v5, 10, v3
    v_lshl_add_u32 v5, v2, 4, v5
    s_add_u32 s7, s6, 0
    buffer_load_dwordx4 v[8:11], v4, s[44:47], s7 offen offset:0 nt
    s_add_u32 s7, s6, 0
    buffer_load_dwordx4 v[12:15], v4, s[44:47], s7 offen offset:64 nt
    s_waitcnt lgkmcnt(0)
    s_barrier
    s_add_u32 s7, s6, 0
    buffer_load_dwordx4 v[16:19], v4, s[44:47], s7 offen offset:128 nt
    s_add_u32 s7, s6, 0
    buffer_load_dwordx4 v[20:23], v4, s[44:47], s7 offen offset:192 nt
    s_add_u32 s7, s6, 4096
    buffer_load_dwordx4 v[24:27], v4, s[44:47], s7 offen offset:0 nt
    s_add_u32 s7, s6, 4096
    buffer_load_dwordx4 v[28:31], v4, s[44:47], s7 offen offset:64 nt
    s_waitcnt vmcnt(5)
    s_add_u32 s7, s6, 4096
    buffer_load_dwordx4 v[32:35], v4, s[44:47], s7 offen offset:128 nt
    s_waitcnt vmcnt(5)
    s_add_u32 s7, s6, 4096
    buffer_load_dwordx4 v[36:39], v4, s[44:47], s7 offen offset:192 nt
    s_waitcnt vmcnt(5)
    s_add_u32 s7, s6, 8192
    buffer_load_dwordx4 v[40:43], v4, s[44:47], s7 offen offset:0 nt
    s_waitcnt vmcnt(5)
    s_add_u32 s7, s6, 8192
    buffer_load_dwordx4 v[44:47], v4, s[44:47], s7 offen offset:64 nt
    s_waitcnt vmcnt(5)
    s_add_u32 s7, s6, 8192
    buffer_load_dwordx4 v[48:51], v4, s[44:47], s7 offen offset:128 nt
    s_waitcnt vmcnt(5)
    s_add_u32 s7, s6, 8192
    buffer_load_dwordx4 v[52:55], v4, s[44:47], s7 offen offset:192 nt
    s_waitcnt vmcnt(5)
    s_add_u32 s7, s6, 12288
    buffer_load_dwordx4 v[56:59], v4, s[44:47], s7 offen offset:0 nt
    s_mov_b64 exec, 1
    v_mov_b32 v2, 0
    v_mov_b32 v3, 1
    ds_add_u32 v2, v3 offset:24
    s_mov_b64 exec, -1
    s_waitcnt vmcnt(5)
    s_add_u32 s7, s6, 12288
    buffer_load_dwordx4 v[60:63], v4, s[44:47], s7 offen offset:64 nt
    s_waitcnt vmcnt(5)
    s_add_u32 s7, s6, 12288
    buffer_load_dwordx4 v[64:67], v4, s[44:47], s7 offen offset:128 nt
    s_waitcnt vmcnt(5)
    s_add_u32 s7, s6, 12288
    buffer_load_dwordx4 v[68:71], v4, s[44:47], s7 offen offset:192 nt
    s_waitcnt vmcnt(15)
    s_add_u32 s7, s6, 0
    buffer_load_dwordx4 v[72:75], v5, s[48:51], s7 offen offset:0 nt
    s_waitcnt vmcnt(15)
    s_add_u32 s7, s6, 0
    buffer_load_dwordx4 v[76:79], v5, s[48:51], s7 offen offset:256 nt
    s_waitcnt vmcnt(15)
    s_add_u32 s7, s6, 0
    buffer_load_dwordx4 v[80:83], v5, s[48:51], s7 offen offset:512 nt
    s_waitcnt vmcnt(15)
    s_add_u32 s7, s6, 0
    buffer_load_dwordx4 v[84:87], v5, s[48:51], s7 offen offset:768 nt
    s_waitcnt vmcnt(15)
    s_add_u32 s7, s6, 4096
    buffer_load_dwordx4 v[88:91], v5, s[48:51], s7 offen offset:0 nt
    s_waitcnt vmcnt(15)
    s_add_u32 s7, s6, 4096
    buffer_load_dwordx4 v[92:95], v5, s[48:51], s7 offen offset:256 nt
    s_waitcnt vmcnt(15)
    s_add_u32 s7, s6, 4096
    buffer_load_dwordx4 v[96:99], v5, s[48:51], s7 offen offset:512 nt
    s_waitcnt vmcnt(15)
    s_add_u32 s7, s6, 4096
    buffer_load_dwordx4 v[100:103], v5, s[48:51], s7 offen offset:768 nt
    s_waitcnt vmcnt(15)
    s_add_u32 s7, s6, 8192
    buffer_load_dwordx4 v[104:107], v5, s[48:51], s7 offen offset:0 nt
    s_waitcnt vmcnt(15)
    s_add_u32 s7, s6, 8192
    buffer_load_dwordx4 v[108:111], v5, s[48:51], s7 offen offset:256 nt
    s_waitcnt vmcnt(15)
    s_add_u32 s7, s6, 8192
    buffer_load_dwordx4 v[112:115], v5, s[48:51], s7 offen offset:512 nt
    s_waitcnt vmcnt(15)
    s_add_u32 s7, s6, 8192
    buffer_load_dwordx4 v[116:119], v5, s[48:51], s7 offen offset:768 nt
    s_waitcnt vmcnt(15)
    s_add_u32 s7, s6, 12288
    buffer_load_dwordx4 v[120:123], v5, s[48:51], s7 offen offset:0 nt
    s_waitcnt vmcnt(15)
    s_add_u32 s7, s6, 12288
    buffer_load_dwordx4 v[124:127], v5, s[48:51], s7 offen offset:256 nt
    s_waitcnt vmcnt(15)
    s_add_u32 s7, s6, 12288
    buffer_load_dwordx4 v[128:131], v5, s[48:51], s7 offen offset:512 nt
    s_waitcnt vmcnt(15)
    s_add_u32 s7, s6, 12288
    buffer_load_dwordx4 v[132:135], v5, s[48:51], s7 offen offset:768 nt
    s_add_u32 s40, s40, 1
    s_mov_b64 exec, 1
    v_mov_b32 v2, 0
    v_mov_b32 v3, 1
    ds_add_u32 v2, v3 offset:8
    s_mov_b64 exec, -1
    s_mov_b32 s41, 400000
    v_mov_b32 v3, 0
L_lw_1:
    ds_read_b32 v2, v3 offset:0
    s_waitcnt lgkmcnt(0)
    v_readfirstlane_b32 s4, v2
    s_nop 3
    s_cmp_ge_u32 s4, 1
    s_cbranch_scc1 L_lwd_2
    s_sleep 1
    s_sub_u32 s41, s41, 1
    s_cmp_lg_u32 s41, 0
    s_cbranch_scc1 L_lw_1
L_lwd_2:
    v_and_b32 v2, 7, v0
    v_lshlrev_b32 v2, 8, v2
    v_lshrrev_b32 v3, 4, v0
    v_lshl_add_u32 v2, v3, 4, v2
    ds_read_b128 v[136:139], v2 offset:1024
    ds_read_b128 v[140:143], v2 offset:1088
    ds_read_b128 v[144:147], v2 offset:1152
    ds_read_b128 v[148:151], v2 offset:1216
    s_waitcnt vmcnt(16) lgkmcnt(0)
    v_mfma_f32_16x16x32_bf16 v[152:155], v[8:11], v[136:139], 0
    v_mfma_f32_16x16x32_bf16 v[152:155], v[12:15], v[140:143], v[152:155]
    v_mfma_f32_16x16x32_bf16 v[152:155], v[16:19], v[144:147], v[152:155]
    v_mfma_f32_16x16x32_bf16 v[152:155], v[20:23], v[148:151], v[152:155]
    v_mfma_f32_16x16x32_bf16 v[156:159], v[24:27], v[136:139], 0
    v_mfma_f32_16x16x32_bf16 v[156:159], v[28:31], v[140:143], v[156:159]
    v_mfma_f32_16x16x32_bf16 v[156:159], v[32:35], v[144:147], v[156:159]
    v_mfma_f32_16x16x32_bf16 v[156:159], v[36:39], v[148:151], v[156:159]
    v_mfma_f32_16x16x32_bf16 v[160:163], v[40:43], v[136:139], 0
    v_mfma_f32_16x16x32_bf16 v[160:163], v[44:47], v[140:143], v[160:163]
    v_mfma_f32_16x16x32_bf16 v[160:163], v[48:51], v[144:147], v[160:163]
    v_mfma_f32_16x16x32_bf16 v[160:163], v[52:55], v[148:151], v[160:163]
    v_mfma_f32_16x16x32_bf16 v[164:167], v[56:59], v[136:139], 0
    v_mfma_f32_16x16x32_bf16 v[164:167], v[60:63], v[140:143], v[164:167]
    v_mfma_f32_16x16x32_bf16 v[164:167], v[64:67], v[144:147], v[164:167]
    v_mfma_f32_16x16x32_bf16 v[164:167], v[68:71], v[148:151], v[164:167]
    s_nop 7
    s_nop 1
    v_cvt_pk_bf16_f32 v2, v152, v153
    v_lshlrev_b32 v152, 16, v2
    v_and_b32 v153, 0xffff0000, v2
    v_mul_f32 v152, s70, v152
    v_mul_f32 v153, s70, v153
    v_cvt_pk_bf16_f32 v2, v152, v153
    v_lshlrev_b32 v152, 16, v2
    v_and_b32 v153, 0xffff0000, v2
    v_cvt_pk_bf16_f32 v2, v154, v155
    v_lshlrev_b32 v154, 16, v2
    v_and_b32 v155, 0xffff0000, v2
    v_mul_f32 v154, s70, v154
    v_mul_f32 v155, s70, v155
    v_cvt_pk_bf16_f32 v2, v154, v155
    v_lshlrev_b32 v154, 16, v2
    v_and_b32 v155, 0xffff0000, v2
    v_cvt_pk_bf16_f32 v2, v156, v157
    v_lshlrev_b32 v156, 16, v2
    v_and_b32 v157, 0xffff0000, v2
    v_mul_f32 v156, s70, v156
    v_mul_f32 v157, s70, v157
    v_cvt_pk_bf16_f32 v2, v156, v157
    v_lshlrev_b32 v156, 16, v2
    v_and_b32 v157, 0xffff0000, v2
    v_cvt_pk_bf16_f32 v2, v158, v159
    v_lshlrev_b32 v158, 16, v2
    v_and_b32 v159, 0xffff0000, v2
    v_mul_f32 v158, s70, v158
    v_mul_f32 v159, s70, v159
    v_cvt_pk_bf16_f32 v2, v158, v159
    v_lshlrev_b32 v158, 16, v2
    v_and_b32 v159, 0xffff0000, v2
    v_cvt_pk_bf16_f32 v2, v160, v161
    v_lshlrev_b32 v160, 16, v2
    v_and_b32 v161, 0xffff0000, v2
    v_mul_f32 v160, s70, v160
    v_mul_f32 v161, s70, v161
    v_cvt_pk_bf16_f32 v2, v160, v161
    v_lshlrev_b32 v160, 16, v2
    v_and_b32 v161, 0xffff0000, v2
    v_cvt_pk_bf16_f32 v2, v162, v163
    v_lshlrev_b32 v162, 16, v2
    v_and_b32 v163, 0xffff0000, v2
    v_mul_f32 v162, s70, v162
    v_mul_f32 v163, s70, v163
    v_cvt_pk_bf16_f32 v2, v162, v163
    v_lshlrev_b32 v162, 16, v2
    v_and_b32 v163, 0xffff0000, v2
    v_cvt_pk_bf16_f32 v2, v164, v165
    v_lshlrev_b32 v164, 16, v2
    v_and_b32 v165, 0xffff0000, v2
    v_mul_f32 v164, s70, v164
    v_mul_f32 v165, s70, v165
    v_cvt_pk_bf16_f32 v2, v164, v165
    v_lshlrev_b32 v164, 16, v2
    v_and_b32 v165, 0xffff0000, v2
    v_cvt_pk_bf16_f32 v2, v166, v167
    v_lshlrev_b32 v166, 16, v2
    v_and_b32 v167, 0xffff0000, v2
    v_mul_f32 v166, s70, v166
    v_mul_f32 v167, s70, v167
    v_cvt_pk_bf16_f32 v2, v166, v167
    v_lshlrev_b32 v166, 16, v2
    v_and_b32 v167, 0xffff0000, v2
    v_max3_f32 v6, v152, v153, v154
    v_max3_f32 v6, v6, v155, v156
    v_max3_f32 v6, v6, v157, v158
    v_max3_f32 v6, v6, v159, v160
    v_max3_f32 v6, v6, v161, v162
    v_max3_f32 v6, v6, v163, v164
    v_max3_f32 v6, v6, v165, v166
    v_max_f32 v6, v6, v167
    v_mov_b32 v7, v6
    s_nop 1
    v_permlane32_swap_b32 v6, v7
    s_nop 1
    v_max_f32 v6, v6, v7
    v_mov_b32 v7, v6
    s_nop 1
    v_permlane16_swap_b32 v6, v7
    s_nop 1
    v_max_f32 v6, v6, v7
    v_mul_f32 v6, s71, v6
    v_fma_f32 v152, v152, s71, -v6
    v_fma_f32 v153, v153, s71, -v6
    v_fma_f32 v154, v154, s71, -v6
    v_fma_f32 v155, v155, s71, -v6
    v_fma_f32 v156, v156, s71, -v6
    v_fma_f32 v157, v157, s71, -v6
    v_fma_f32 v158, v158, s71, -v6
    v_fma_f32 v159, v159, s71, -v6
    v_fma_f32 v160, v160, s71, -v6
    v_fma_f32 v161, v161, s71, -v6
    v_fma_f32 v162, v162, s71, -v6
    v_fma_f32 v163, v163, s71, -v6
    v_fma_f32 v164, v164, s71, -v6
    v_fma_f32 v165, v165, s71, -v6
    v_fma_f32 v166, v166, s71, -v6
    v_fma_f32 v167, v167, s71, -v6
    v_exp_f32 v152, v152
    v_exp_f32 v153, v153
    v_exp_f32 v154, v154
    v_exp_f32 v155, v155
    v_exp_f32 v156, v156
    v_exp_f32 v157, v157
    v_exp_f32 v158, v158
    v_exp_f32 v159, v159
    v_exp_f32 v160, v160
    v_exp_f32 v161, v161
    v_exp_f32 v162, v162
    v_exp_f32 v163, v163
    v_exp_f32 v164, v164
    v_exp_f32 v165, v165
    v_exp_f32 v166, v166
    v_exp_f32 v167, v167
    s_nop 0
    v_add_f32 v7, v152, v153
    v_add_f32 v7, v7, v154
    v_add_f32 v7, v7, v155
    v_add_f32 v7, v7, v156
    v_add_f32 v7, v7, v157
    v_add_f32 v7, v7, v158
    v_add_f32 v7, v7, v159
    v_add_f32 v7, v7, v160
    v_add_f32 v7, v7, v161
    v_add_f32 v7, v7, v162
    v_add_f32 v7, v7, v163
    v_add_f32 v7, v7, v164
    v_add_f32 v7, v7, v165
    v_add_f32 v7, v7, v166
    v_add_f32 v7, v7, v167
    v_mov_b32 v2, v7
    s_nop 1
    v_permlane32_swap_b32 v7, v2
    s_nop 1
    v_add_f32 v7, v7, v2
    v_mov_b32 v2, v7
    s_nop 1
    v_permlane16_swap_b32 v7, v2
    s_nop 1
    v_add_f32 v7, v7, v2
    v_cvt_pk_bf16_f32 v56, v152, v153
    v_cvt_pk_bf16_f32 v57, v154, v155
    v_cvt_pk_bf16_f32 v58, v156, v157
    v_cvt_pk_bf16_f32 v59, v158, v159
    v_cvt_pk_bf16_f32 v60, v160, v161
    v_cvt_pk_bf16_f32 v61, v162, v163
    v_cvt_pk_bf16_f32 v62, v164, v165
    v_cvt_pk_bf16_f32 v63, v166, v167
    s_waitcnt vmcnt(8)
    v_perm_b32 v40, v76, v72, s68
    v_perm_b32 v41, v84, v80, s68
    v_perm_b32 v42, v92, v88, s68
    v_perm_b32 v43, v100, v96, s68
    v_perm_b32 v44, v76, v72, s69
    v_perm_b32 v45, v84, v80, s69
    v_perm_b32 v46, v92, v88, s69
    v_perm_b32 v47, v100, v96, s69
    s_nop 1
    v_mfma_f32_16x16x32_bf16 v[8:11], v[56:59], v[40:43], 0
    v_mfma_f32_16x16x32_bf16 v[12:15], v[56:59], v[44:47], 0
    v_perm_b32 v48, v77, v73, s68
    v_perm_b32 v49, v85, v81, s68
    v_perm_b32 v50, v93, v89, s68
    v_perm_b32 v51, v101, v97, s68
    v_perm_b32 v52, v77, v73, s69
    v_perm_b32 v53, v85, v81, s69
    v_perm_b32 v54, v93, v89, s69
    v_perm_b32 v55, v101, v97, s69
    s_nop 1
    v_mfma_f32_16x16x32_bf16 v[16:19], v[56:59], v[48:51], 0
    v_mfma_f32_16x16x32_bf16 v[20:23], v[56:59], v[52:55], 0
    v_perm_b32 v40, v78, v74, s68
    v_perm_b32 v41, v86, v82, s68
    v_perm_b32 v42, v94, v90, s68
    v_perm_b32 v43, v102, v98, s68
    v_perm_b32 v44, v78, v74, s69
    v_perm_b32 v45, v86, v82, s69
    v_perm_b32 v46, v94, v90, s69
    v_perm_b32 v47, v102, v98, s69
    s_nop 1
    v_mfma_f32_16x16x32_bf16 v[24:27], v[56:59], v[40:43], 0
    v_mfma_f32_16x16x32_bf16 v[28:31], v[56:59], v[44:47], 0
    v_perm_b32 v48, v79, v75, s68
    v_perm_b32 v49, v87, v83, s68
    v_perm_b32 v50, v95, v91, s68
    v_perm_b32 v51, v103, v99, s68
    v_perm_b32 v52, v79, v75, s69
    v_perm_b32 v53, v87, v83, s69
    v_perm_b32 v54, v95, v91, s69
    v_perm_b32 v55, v103, v99, s69
    s_nop 1
    v_mfma_f32_16x16x32_bf16 v[32:35], v[56:59], v[48:51], 0
    v_mfma_f32_16x16x32_bf16 v[36:39], v[56:59], v[52:55], 0
    s_waitcnt vmcnt(0)
    v_perm_b32 v40, v108, v104, s68
    v_perm_b32 v41, v116, v112, s68
    v_perm_b32 v42, v124, v120, s68
    v_perm_b32 v43, v132, v128, s68
    v_perm_b32 v44, v108, v104, s69
    v_perm_b32 v45, v116, v112, s69
    v_perm_b32 v46, v124, v120, s69
    v_perm_b32 v47, v132, v128, s69
    s_nop 1
    v_mfma_f32_16x16x32_bf16 v[8:11], v[60:63], v[40:43], v[8:11]
    v_mfma_f32_16x16x32_bf16 v[12:15], v[60:63], v[44:47], v[12:15]
    v_perm_b32 v48, v109, v105, s68
    v_perm_b32 v49, v117, v113, s68
    v_perm_b32 v50, v125, v121, s68
    v_perm_b32 v51, v133, v129, s68
    v_perm_b32 v52, v109, v105, s69
    v_perm_b32 v53, v117, v113, s69
    v_perm_b32 v54, v125, v121, s69
    v_perm_b32 v55, v133, v129, s69
    s_nop 1
    v_mfma_f32_16x16x32_bf16 v[16:19], v[60:63], v[48:51], v[16:19]
    v_mfma_f32_16x16x32_bf16 v[20:23], v[60:63], v[52:55], v[20:23]
    v_perm_b32 v40, v110, v106, s68
    v_perm_b32 v41, v118, v114, s68
    v_perm_b32 v42, v126, v122, s68
    v_perm_b32 v43, v134, v130, s68
    v_perm_b32 v44, v110, v106, s69
    v_perm_b32 v45, v118, v114, s69
    v_perm_b32 v46, v126, v122, s69
    v_perm_b32 v47, v134, v130, s69
    s_nop 1
    v_mfma_f32_16x16x32_bf16 v[24:27], v[60:63], v[40:43], v[24:27]
    v_mfma_f32_16x16x32_bf16 v[28:31], v[60:63], v[44:47], v[28:31]
    v_perm_b32 v48, v111, v107, s68
    v_perm_b32 v49, v119, v115, s68
    v_perm_b32 v50, v127, v123, s68
    v_perm_b32 v51, v135, v131, s68
    v_perm_b32 v52, v111, v107, s69
    v_perm_b32 v53, v119, v115, s69
    v_perm_b32 v54, v127, v123, s69
    v_perm_b32 v55, v135, v131, s69
    s_nop 1
    v_mfma_f32_16x16x32_bf16 v[32:35], v[60:63], v[48:51], v[32:35]
    v_mfma_f32_16x16x32_bf16 v[36:39], v[60:63], v[52:55], v[36:39]
    s_nop 7
    s_nop 1
    v_mov_b32 v72, v8
    v_mov_b32 v73, v12
    v_mov_b32 v74, v16
    v_mov_b32 v75, v20
    v_mov_b32 v76, v24
    v_mov_b32 v77, v28
    v_mov_b32 v78, v32
    v_mov_b32 v79, v36
    v_mov_b32 v80, v9
    v_mov_b32 v81, v13
    v_mov_b32 v82, v17
    v_mov_b32 v83, v21
    v_mov_b32 v84, v25
    v_mov_b32 v85, v29
    v_mov_b32 v86, v33
    v_mov_b32 v87, v37
    v_mov_b32 v88, v10
    v_mov_b32 v89, v14
    v_mov_b32 v90, v18
    v_mov_b32 v91, v22
    v_mov_b32 v92, v26
    v_mov_b32 v93, v30
    v_mov_b32 v94, v34
    v_mov_b32 v95, v38
    v_mov_b32 v96, v11
    v_mov_b32 v97, v15
    v_mov_b32 v98, v19
    v_mov_b32 v99, v23
    v_mov_b32 v100, v27
    v_mov_b32 v101, v31
    v_mov_b32 v102, v35
    v_mov_b32 v103, v39
    v_lshrrev_b32 v2, 4, v0
    v_lshlrev_b32 v2, 11, v2
    v_and_b32 v3, 15, v0
    v_lshl_add_u32 v2, v3, 5, v2
    s_lshl_b32 s5, s3, 12
    v_add_u32 v2, s5, v2
    s_mov_b32 exec_lo, -1
    s_mov_b32 exec_hi, 0
    ds_write_b128 v2, v[72:75] offset:8192
    ds_write_b128 v2, v[76:79] offset:8208
    ds_write_b128 v2, v[80:83] offset:8704
    ds_write_b128 v2, v[84:87] offset:8720
    ds_write_b128 v2, v[88:91] offset:9216
    ds_write_b128 v2, v[92:95] offset:9232
    ds_write_b128 v2, v[96:99] offset:9728
    ds_write_b128 v2, v[100:103] offset:9744
    s_mov_b64 exec, -1
    v_and_b32 v2, 7, v0
    v_lshlrev_b32 v2, 3, v2
    s_lshl_b32 s5, s3, 6
    v_add_u32 v2, s5, v2
    ds_write_b64 v2, v[6:7] offset:256
    s_mov_b64 exec, 1
    v_mov_b32 v2, 0
    v_mov_b32 v3, 1
    ds_add_u32 v2, v3 offset:4
    s_mov_b64 exec, -1
    s_mov_b32 s41, 400000
    v_mov_b32 v3, 0
L_lw_3:
    ds_read_b32 v2, v3 offset:4
    s_waitcnt lgkmcnt(0)
    v_readfirstlane_b32 s4, v2
    s_nop 3
    s_cmp_ge_u32 s4, 8
    s_cbranch_scc1 L_lwd_4
    s_sleep 1
    s_sub_u32 s41, s41, 1
    s_cmp_lg_u32 s41, 0
    s_cbranch_scc1 L_lw_3
L_lwd_4:
    s_lshl_b32 s5, s3, 3
    v_mov_b32 v2, s5
    ds_read_b64 v[8:9], v2 offset:256
    ds_read_b64 v[10:11], v2 offset:320
    ds_read_b64 v[12:13], v2 offset:384
    ds_read_b64 v[14:15], v2 offset:448
    ds_read_b64 v[16:17], v2 offset:512
    ds_read_b64 v[18:19], v2 offset:576
    ds_read_b64 v[20:21], v2 offset:640
    ds_read_b64 v[22:23], v2 offset:704
    s_lshl_b32 s5, s3, 9
    v_and_b32 v3, 31, v0
    v_lshlrev_b32 v3, 4, v3
    v_add_u32 v3, s5, v3
    ds_read_b128 v[24:27], v3 offset:8192
    ds_read_b128 v[28:31], v3 offset:12288
    ds_read_b128 v[32:35], v3 offset:16384
    ds_read_b128 v[36:39], v3 offset:20480
    ds_read_b128 v[40:43], v3 offset:24576
    ds_read_b128 v[44:47], v3 offset:28672
    ds_read_b128 v[48:51], v3 offset:32768
    ds_read_b128 v[52:55], v3 offset:36864
    v_mov_b32 v64, s40
    v_mov_b32 v65, s40
    v_lshrrev_b32 v65, 8, v65
    v_mov_b32 v66, s40
    v_lshrrev_b32 v66, 16, v66
    v_mov_b32 v67, s40
    v_lshrrev_b32 v67, 24, v67
    s_waitcnt lgkmcnt(8)
    v_max3_f32 v4, v8, v10, v12
    v_max3_f32 v4, v4, v14, v16
    v_max3_f32 v4, v4, v18, v20
    v_max_f32 v4, v4, v22
    v_sub_f32 v8, v8, v4
    v_sub_f32 v10, v10, v4
    v_sub_f32 v12, v12, v4
    v_sub_f32 v14, v14, v4
    v_sub_f32 v16, v16, v4
    v_sub_f32 v18, v18, v4
    v_sub_f32 v20, v20, v4
    v_sub_f32 v22, v22, v4
    v_exp_f32 v8, v8
    v_exp_f32 v10, v10
    v_exp_f32 v12, v12
    v_exp_f32 v14, v14
    v_exp_f32 v16, v16
    v_exp_f32 v18, v18
    v_exp_f32 v20, v20
    v_exp_f32 v22, v22
    s_waitcnt lgkmcnt(0)
    v_mul_f32 v5, v8, v9
    v_mul_f32 v60, v8, v24
    v_mul_f32 v61, v8, v25
    v_mul_f32 v62, v8, v26
    v_mul_f32 v63, v8, v27
    v_fmac_f32 v5, v10, v11
    v_fmac_f32 v60, v10, v28
    v_fmac_f32 v61, v10, v29
    v_fmac_f32 v62, v10, v30
    v_fmac_f32 v63, v10, v31
    v_fmac_f32 v5, v12, v13
    v_fmac_f32 v60, v12, v32
    v_fmac_f32 v61, v12, v33
    v_fmac_f32 v62, v12, v34
    v_fmac_f32 v63, v12, v35
    v_fmac_f32 v5, v14, v15
    v_fmac_f32 v60, v14, v36
    v_fmac_f32 v61, v14, v37
    v_fmac_f32 v62, v14, v38
    v_fmac_f32 v63, v14, v39
    v_fmac_f32 v5, v16, v17
    v_fmac_f32 v60, v16, v40
    v_fmac_f32 v61, v16, v41
    v_fmac_f32 v62, v16, v42
    v_fmac_f32 v63, v16, v43
    v_fmac_f32 v5, v18, v19
    v_fmac_f32 v60, v18, v44
    v_fmac_f32 v61, v18, v45
    v_fmac_f32 v62, v18, v46
    v_fmac_f32 v63, v18, v47
    v_fmac_f32 v5, v20, v21
    v_fmac_f32 v60, v20, v48
    v_fmac_f32 v61, v20, v49
    v_fmac_f32 v62, v20, v50
    v_fmac_f32 v63, v20, v51
    v_fmac_f32 v5, v22, v23
    v_fmac_f32 v60, v22, v52
    v_fmac_f32 v61, v22, v53
    v_fmac_f32 v62, v22, v54
    v_fmac_f32 v63, v22, v55
    v_bfi_b32 v60, s42, v64, v60
    v_bfi_b32 v61, s42, v65, v61
    v_bfi_b32 v62, s42, v66, v62
    v_bfi_b32 v63, s42, v67, v63
    s_lshr_b32 s5, s96, 4
    s_and_b32 s5, s5, 3
    s_lshl_b32 s5, s5, 3
    s_add_u32 s5, s5, s3
    s_lshl_b32 s5, s5, 2
    s_lshr_b32 s6, s96, 6
    s_add_u32 s5, s5, s6
    s_lshl_b32 s5, s5, 4
    s_and_b32 s6, s96, 15
    s_add_u32 s5, s5, s6
    s_lshl_b32 s5, s5, 10
    s_add_u32 s5, s5, 4194304
    v_lshlrev_b32 v3, 4, v0
    v_mov_b32 v6, s40
    v_mov_b32 v7, s40
    s_mov_b32 exec_lo, -1
    s_mov_b32 exec_hi, 0
    buffer_store_dwordx4 v[60:63], v3, s[56:59], s5 offen sc1
    s_mov_b64 exec, 1
    buffer_store_dwordx4 v[4:7], v3, s[56:59], s5 offen offset:512 sc1
    s_mov_b64 exec, -1
    s_mov_b64 exec, 1
    v_mov_b32 v2, 0
    v_mov_b32 v3, 1
    ds_add_u32 v2, v3 offset:20
    s_mov_b64 exec, -1
    s_endpgm
L_notattn:
    s_setprio 3
    s_cmp_eq_u32 s3, 11
    s_cbranch_scc1 L_comm
    s_cmp_eq_u32 s3, 8
    s_cbranch_scc1 L_w8
    s_cmp_lt_u32 s2, 224
    s_cbranch_scc1 L_ffn
    s_waitcnt lgkmcnt(0)
    s_barrier
    s_endpgm
L_ffn:
    s_cmp_eq_u32 s3, 9
    s_cselect_b32 s52, s28, s30
    s_cselect_b32 s53, s29, s31
    s_mov_b32 s54, 7340032
    s_mov_b32 s55, 0x00020000
    s_lshr_b32 s8, s2, 3
    s_and_b32 s9, s2, 7
    s_lshl_b32 s10, s9, 8
    v_lshrrev_b32 v2, 4, v0
    v_lshlrev_b32 v2, 11, v2
    v_and_b32 v3, 15, v0
    v_lshlrev_b32 v3, 7, v3
    v_add_u32 v2, v2, v3
    buffer_load_dwordx4 v[8:11], v2, s[60:63], 0 offen offset:0
    buffer_load_dwordx4 v[12:15], v2, s[60:63], 0 offen offset:16
    buffer_load_dwordx4 v[16:19], v2, s[60:63], 0 offen offset:32
    buffer_load_dwordx4 v[20:23], v2, s[60:63], 0 offen offset:48
    buffer_load_dwordx4 v[24:27], v2, s[60:63], 0 offen offset:64
    buffer_load_dwordx4 v[28:31], v2, s[60:63], 0 offen offset:80
    buffer_load_dwordx4 v[32:35], v2, s[60:63], 0 offen offset:96
    buffer_load_dwordx4 v[36:39], v2, s[60:63], 0 offen offset:112
    v_and_b32 v3, 3, v0
    v_lshlrev_b32 v3, 11, v3
    v_lshrrev_b32 v4, 4, v0
    v_lshlrev_b32 v4, 4, v4
    v_add_u32 v3, v3, v4
    buffer_load_dwordx4 v[120:123], v3, s[60:63], s10 offen offset:0
    buffer_load_dwordx4 v[124:127], v3, s[60:63], s10 offen offset:64
    buffer_load_dwordx4 v[128:131], v3, s[60:63], s10 offen offset:128
    buffer_load_dwordx4 v[132:135], v3, s[60:63], s10 offen offset:192
    v_lshrrev_b32 v2, 4, v0
    s_mov_b32 s5, 57344
    v_mul_lo_u32 v2, v2, s5
    v_and_b32 v1, 15, v0
    v_lshlrev_b32 v1, 4, v1
    v_add_u32 v1, v1, v2
    s_mul_i32 s11, s9, 917504
    s_lshl_b32 s12, s8, 8
    s_add_u32 s11, s11, s12
    s_sub_u32 s13, s3, 8
    s_lshl_b32 s13, s13, 15
    s_add_u32 s13, s13, 40960
    s_add_u32 s5, s11, 0
    s_add_u32 s14, s13, 0
    s_mov_b32 m0, s14
    s_nop 0
    buffer_load_dwordx4 v1, s[52:55], s5 offen nt lds
    s_add_u32 s5, s11, 7168
    s_add_u32 s14, s13, 1024
    s_mov_b32 m0, s14
    s_nop 0
    buffer_load_dwordx4 v1, s[52:55], s5 offen nt lds
    s_waitcnt lgkmcnt(0)
    s_barrier
    s_add_u32 s5, s11, 14336
    s_add_u32 s14, s13, 2048
    s_mov_b32 m0, s14
    s_nop 0
    buffer_load_dwordx4 v1, s[52:55], s5 offen nt lds
    s_add_u32 s5, s11, 21504
    s_add_u32 s14, s13, 3072
    s_mov_b32 m0, s14
    s_nop 0
    buffer_load_dwordx4 v1, s[52:55], s5 offen nt lds
    s_add_u32 s5, s11, 28672
    s_add_u32 s14, s13, 4096
    s_mov_b32 m0, s14
    s_nop 0
    buffer_load_dwordx4 v1, s[52:55], s5 offen nt lds
    s_add_u32 s5, s11, 35840
    s_add_u32 s14, s13, 5120
    s_mov_b32 m0, s14
    s_nop 0
    buffer_load_dwordx4 v1, s[52:55], s5 offen nt lds
    s_add_u32 s5, s11, 43008
    s_add_u32 s14, s13, 6144
    s_mov_b32 m0, s14
    s_nop 0
    buffer_load_dwordx4 v1, s[52:55], s5 offen nt lds
    s_add_u32 s5, s11, 50176
    s_add_u32 s14, s13, 7168
    s_mov_b32 m0, s14
    s_nop 0
    buffer_load_dwordx4 v1, s[52:55], s5 offen nt lds
    s_add_u32 s5, s11, 229376
    s_add_u32 s14, s13, 8192
    s_mov_b32 m0, s14
    s_nop 0
    buffer_load_dwordx4 v1, s[52:55], s5 offen nt lds
    s_add_u32 s5, s11, 236544
    s_add_u32 s14, s13, 9216
    s_mov_b32 m0, s14
    s_nop 0
    buffer_load_dwordx4 v1, s[52:55], s5 offen nt lds
    s_add_u32 s5, s11, 243712
    s_add_u32 s14, s13, 10240
    s_mov_b32 m0, s14
    s_nop 0
    buffer_load_dwordx4 v1, s[52:55], s5 offen nt lds
    s_add_u32 s5, s11, 250880
    s_add_u32 s14, s13, 11264
    s_mov_b32 m0, s14
    s_nop 0
    buffer_load_dwordx4 v1, s[52:55], s5 offen nt lds
    s_add_u32 s5, s11, 258048
    s_add_u32 s14, s13, 12288
    s_mov_b32 m0, s14
    s_nop 0
    buffer_load_dwordx4 v1, s[52:55], s5 offen nt lds
    s_add_u32 s5, s11, 265216
    s_add_u32 s14, s13, 13312
    s_mov_b32 m0, s14
    s_nop 0
    buffer_load_dwordx4 v1, s[52:55], s5 offen nt lds
    s_add_u32 s5, s11, 272384
    s_add_u32 s14, s13, 14336
    s_mov_b32 m0, s14
    s_nop 0
    buffer_load_dwordx4 v1, s[52:55], s5 offen nt lds
    s_add_u32 s5, s11, 279552
    s_add_u32 s14, s13, 15360
    s_mov_b32 m0, s14
    s_nop 0
    buffer_load_dwordx4 v1, s[52:55], s5 offen nt lds
    s_add_u32 s5, s11, 458752
    s_add_u32 s14, s13, 16384
    s_mov_b32 m0, s14
    s_nop 0
    buffer_load_dwordx4 v1, s[52:55], s5 offen nt lds
    s_add_u32 s5, s11, 465920
    s_add_u32 s14, s13, 17408
    s_mov_b32 m0, s14
    s_nop 0
    buffer_load_dwordx4 v1, s[52:55], s5 offen nt lds
    s_add_u32 s5, s11, 473088
    s_add_u32 s14, s13, 18432
    s_mov_b32 m0, s14
    s_nop 0
    buffer_load_dwordx4 v1, s[52:55], s5 offen nt lds
    s_add_u32 s5, s11, 480256
    s_add_u32 s14, s13, 19456
    s_mov_b32 m0, s14
    s_nop 0
    buffer_load_dwordx4 v1, s[52:55], s5 offen nt lds
    s_add_u32 s5, s11, 487424
    s_add_u32 s14, s13, 20480
    s_mov_b32 m0, s14
    s_nop 0
    buffer_load_dwordx4 v1, s[52:55], s5 offen nt lds
    s_add_u32 s5, s11, 494592
    s_add_u32 s14, s13, 21504
    s_mov_b32 m0, s14
    s_nop 0
    buffer_load_dwordx4 v1, s[52:55], s5 offen nt lds
    s_add_u32 s5, s11, 501760
    s_add_u32 s14, s13, 22528
    s_mov_b32 m0, s14
    s_nop 0
    buffer_load_dwordx4 v1, s[52:55], s5 offen nt lds
    s_add_u32 s5, s11, 508928
    s_add_u32 s14, s13, 23552
    s_mov_b32 m0, s14
    s_nop 0
    buffer_load_dwordx4 v1, s[52:55], s5 offen nt lds
    s_add_u32 s5, s11, 688128
    s_add_u32 s14, s13, 24576
    s_mov_b32 m0, s14
    s_nop 0
    buffer_load_dwordx4 v1, s[52:55], s5 offen nt lds
    s_add_u32 s5, s11, 695296
    s_add_u32 s14, s13, 25600
    s_mov_b32 m0, s14
    s_nop 0
    buffer_load_dwordx4 v1, s[52:55], s5 offen nt lds
    s_add_u32 s5, s11, 702464
    s_add_u32 s14, s13, 26624
    s_mov_b32 m0, s14
    s_nop 0
    buffer_load_dwordx4 v1, s[52:55], s5 offen nt lds
    s_add_u32 s5, s11, 709632
    s_add_u32 s14, s13, 27648
    s_mov_b32 m0, s14
    s_nop 0
    buffer_load_dwordx4 v1, s[52:55], s5 offen nt lds
    s_add_u32 s5, s11, 716800
    s_add_u32 s14, s13, 28672
    s_mov_b32 m0, s14
    s_nop 0
    buffer_load_dwordx4 v1, s[52:55], s5 offen nt lds
    s_add_u32 s5, s11, 723968
    s_add_u32 s14, s13, 29696
    s_mov_b32 m0, s14
    s_nop 0
    buffer_load_dwordx4 v1, s[52:55], s5 offen nt lds
    s_add_u32 s5, s11, 731136
    s_add_u32 s14, s13, 30720
    s_mov_b32 m0, s14
    s_nop 0
    buffer_load_dwordx4 v1, s[52:55], s5 offen nt lds
    s_add_u32 s5, s11, 738304
    s_add_u32 s14, s13, 31744
    s_mov_b32 m0, s14
    s_nop 0
    buffer_load_dwordx4 v1, s[52:55], s5 offen nt lds
    s_add_u32 s40, s40, 1
    s_waitcnt vmcnt(32)
    v_mov_b32 v160, v1
    v_mov_b32 v2, 0
    v_mov_b32 v3, 0
    v_lshlrev_b32 v4, 16, v8
    v_and_b32 v5, 0xffff0000, v8
    v_add_f32 v2, v2, v4
    v_add_f32 v3, v3, v5
    v_lshlrev_b32 v4, 16, v9
    v_and_b32 v5, 0xffff0000, v9
    v_add_f32 v2, v2, v4
    v_add_f32 v3, v3, v5
    v_lshlrev_b32 v4, 16, v10
    v_and_b32 v5, 0xffff0000, v10
    v_add_f32 v2, v2, v4
    v_add_f32 v3, v3, v5
    v_lshlrev_b32 v4, 16, v11
    v_and_b32 v5, 0xffff0000, v11
    v_add_f32 v2, v2, v4
    v_add_f32 v3, v3, v5
    v_lshlrev_b32 v4, 16, v12
    v_and_b32 v5, 0xffff0000, v12
    v_add_f32 v2, v2, v4
    v_add_f32 v3, v3, v5
    v_lshlrev_b32 v4, 16, v13
    v_and_b32 v5, 0xffff0000, v13
    v_add_f32 v2, v2, v4
    v_add_f32 v3, v3, v5
    v_lshlrev_b32 v4, 16, v14
    v_and_b32 v5, 0xffff0000, v14
    v_add_f32 v2, v2, v4
    v_add_f32 v3, v3, v5
    v_lshlrev_b32 v4, 16, v15
    v_and_b32 v5, 0xffff0000, v15
    v_add_f32 v2, v2, v4
    v_add_f32 v3, v3, v5
    v_lshlrev_b32 v4, 16, v16
    v_and_b32 v5, 0xffff0000, v16
    v_add_f32 v2, v2, v4
    v_add_f32 v3, v3, v5
    v_lshlrev_b32 v4, 16, v17
    v_and_b32 v5, 0xffff0000, v17
    v_add_f32 v2, v2, v4
    v_add_f32 v3, v3, v5
    v_lshlrev_b32 v4, 16, v18
    v_and_b32 v5, 0xffff0000, v18
    v_add_f32 v2, v2, v4
    v_add_f32 v3, v3, v5
    v_lshlrev_b32 v4, 16, v19
    v_and_b32 v5, 0xffff0000, v19
    v_add_f32 v2, v2, v4
    v_add_f32 v3, v3, v5
    v_lshlrev_b32 v4, 16, v20
    v_and_b32 v5, 0xffff0000, v20
    v_add_f32 v2, v2, v4
    v_add_f32 v3, v3, v5
    v_lshlrev_b32 v4, 16, v21
    v_and_b32 v5, 0xffff0000, v21
    v_add_f32 v2, v2, v4
    v_add_f32 v3, v3, v5
    v_lshlrev_b32 v4, 16, v22
    v_and_b32 v5, 0xffff0000, v22
    v_add_f32 v2, v2, v4
    v_add_f32 v3, v3, v5
    v_lshlrev_b32 v4, 16, v23
    v_and_b32 v5, 0xffff0000, v23
    v_add_f32 v2, v2, v4
    v_add_f32 v3, v3, v5
    v_lshlrev_b32 v4, 16, v24
    v_and_b32 v5, 0xffff0000, v24
    v_add_f32 v2, v2, v4
    v_add_f32 v3, v3, v5
    v_lshlrev_b32 v4, 16, v25
    v_and_b32 v5, 0xffff0000, v25
    v_add_f32 v2, v2, v4
    v_add_f32 v3, v3, v5
    v_lshlrev_b32 v4, 16, v26
    v_and_b32 v5, 0xffff0000, v26
    v_add_f32 v2, v2, v4
    v_add_f32 v3, v3, v5
    v_lshlrev_b32 v4, 16, v27
    v_and_b32 v5, 0xffff0000, v27
    v_add_f32 v2, v2, v4
    v_add_f32 v3, v3, v5
    v_lshlrev_b32 v4, 16, v28
    v_and_b32 v5, 0xffff0000, v28
    v_add_f32 v2, v2, v4
    v_add_f32 v3, v3, v5
    v_lshlrev_b32 v4, 16, v29
    v_and_b32 v5, 0xffff0000, v29
    v_add_f32 v2, v2, v4
    v_add_f32 v3, v3, v5
    v_lshlrev_b32 v4, 16, v30
    v_and_b32 v5, 0xffff0000, v30
    v_add_f32 v2, v2, v4
    v_add_f32 v3, v3, v5
    v_lshlrev_b32 v4, 16, v31
    v_and_b32 v5, 0xffff0000, v31
    v_add_f32 v2, v2, v4
    v_add_f32 v3, v3, v5
    v_lshlrev_b32 v4, 16, v32
    v_and_b32 v5, 0xffff0000, v32
    v_add_f32 v2, v2, v4
    v_add_f32 v3, v3, v5
    v_lshlrev_b32 v4, 16, v33
    v_and_b32 v5, 0xffff0000, v33
    v_add_f32 v2, v2, v4
    v_add_f32 v3, v3, v5
    v_lshlrev_b32 v4, 16, v34
    v_and_b32 v5, 0xffff0000, v34
    v_add_f32 v2, v2, v4
    v_add_f32 v3, v3, v5
    v_lshlrev_b32 v4, 16, v35
    v_and_b32 v5, 0xffff0000, v35
    v_add_f32 v2, v2, v4
    v_add_f32 v3, v3, v5
    v_lshlrev_b32 v4, 16, v36
    v_and_b32 v5, 0xffff0000, v36
    v_add_f32 v2, v2, v4
    v_add_f32 v3, v3, v5
    v_lshlrev_b32 v4, 16, v37
    v_and_b32 v5, 0xffff0000, v37
    v_add_f32 v2, v2, v4
    v_add_f32 v3, v3, v5
    v_lshlrev_b32 v4, 16, v38
    v_and_b32 v5, 0xffff0000, v38
    v_add_f32 v2, v2, v4
    v_add_f32 v3, v3, v5
    v_lshlrev_b32 v4, 16, v39
    v_and_b32 v5, 0xffff0000, v39
    v_add_f32 v2, v2, v4
    v_add_f32 v3, v3, v5
    v_add_f32 v2, v2, v3
    s_nop 1
    v_add_f32_dpp v2, v2, v2 row_ror:8 row_mask:0xf bank_mask:0xf
    s_nop 1
    v_add_f32_dpp v2, v2, v2 row_ror:4 row_mask:0xf bank_mask:0xf
    s_nop 1
    v_add_f32_dpp v2, v2, v2 row_ror:2 row_mask:0xf bank_mask:0xf
    s_nop 1
    v_add_f32_dpp v2, v2, v2 row_ror:1 row_mask:0xf bank_mask:0xf
    v_mul_f32 v2, 0x3a800000, v2
    v_mov_b32 v3, 0
    v_mov_b32 v6, 0
    v_lshlrev_b32 v4, 16, v8
    v_and_b32 v5, 0xffff0000, v8
    v_sub_f32 v4, v4, v2
    v_sub_f32 v5, v5, v2
    v_fmac_f32 v3, v4, v4
    v_fmac_f32 v6, v5, v5
    v_lshlrev_b32 v4, 16, v9
    v_and_b32 v5, 0xffff0000, v9
    v_sub_f32 v4, v4, v2
    v_sub_f32 v5, v5, v2
    v_fmac_f32 v3, v4, v4
    v_fmac_f32 v6, v5, v5
    v_lshlrev_b32 v4, 16, v10
    v_and_b32 v5, 0xffff0000, v10
    v_sub_f32 v4, v4, v2
    v_sub_f32 v5, v5, v2
    v_fmac_f32 v3, v4, v4
    v_fmac_f32 v6, v5, v5
    v_lshlrev_b32 v4, 16, v11
    v_and_b32 v5, 0xffff0000, v11
    v_sub_f32 v4, v4, v2
    v_sub_f32 v5, v5, v2
    v_fmac_f32 v3, v4, v4
    v_fmac_f32 v6, v5, v5
    v_lshlrev_b32 v4, 16, v12
    v_and_b32 v5, 0xffff0000, v12
    v_sub_f32 v4, v4, v2
    v_sub_f32 v5, v5, v2
    v_fmac_f32 v3, v4, v4
    v_fmac_f32 v6, v5, v5
    v_lshlrev_b32 v4, 16, v13
    v_and_b32 v5, 0xffff0000, v13
    v_sub_f32 v4, v4, v2
    v_sub_f32 v5, v5, v2
    v_fmac_f32 v3, v4, v4
    v_fmac_f32 v6, v5, v5
    v_lshlrev_b32 v4, 16, v14
    v_and_b32 v5, 0xffff0000, v14
    v_sub_f32 v4, v4, v2
    v_sub_f32 v5, v5, v2
    v_fmac_f32 v3, v4, v4
    v_fmac_f32 v6, v5, v5
    v_lshlrev_b32 v4, 16, v15
    v_and_b32 v5, 0xffff0000, v15
    v_sub_f32 v4, v4, v2
    v_sub_f32 v5, v5, v2
    v_fmac_f32 v3, v4, v4
    v_fmac_f32 v6, v5, v5
    v_lshlrev_b32 v4, 16, v16
    v_and_b32 v5, 0xffff0000, v16
    v_sub_f32 v4, v4, v2
    v_sub_f32 v5, v5, v2
    v_fmac_f32 v3, v4, v4
    v_fmac_f32 v6, v5, v5
    v_lshlrev_b32 v4, 16, v17
    v_and_b32 v5, 0xffff0000, v17
    v_sub_f32 v4, v4, v2
    v_sub_f32 v5, v5, v2
    v_fmac_f32 v3, v4, v4
    v_fmac_f32 v6, v5, v5
    v_lshlrev_b32 v4, 16, v18
    v_and_b32 v5, 0xffff0000, v18
    v_sub_f32 v4, v4, v2
    v_sub_f32 v5, v5, v2
    v_fmac_f32 v3, v4, v4
    v_fmac_f32 v6, v5, v5
    v_lshlrev_b32 v4, 16, v19
    v_and_b32 v5, 0xffff0000, v19
    v_sub_f32 v4, v4, v2
    v_sub_f32 v5, v5, v2
    v_fmac_f32 v3, v4, v4
    v_fmac_f32 v6, v5, v5
    v_lshlrev_b32 v4, 16, v20
    v_and_b32 v5, 0xffff0000, v20
    v_sub_f32 v4, v4, v2
    v_sub_f32 v5, v5, v2
    v_fmac_f32 v3, v4, v4
    v_fmac_f32 v6, v5, v5
    v_lshlrev_b32 v4, 16, v21
    v_and_b32 v5, 0xffff0000, v21
    v_sub_f32 v4, v4, v2
    v_sub_f32 v5, v5, v2
    v_fmac_f32 v3, v4, v4
    v_fmac_f32 v6, v5, v5
    v_lshlrev_b32 v4, 16, v22
    v_and_b32 v5, 0xffff0000, v22
    v_sub_f32 v4, v4, v2
    v_sub_f32 v5, v5, v2
    v_fmac_f32 v3, v4, v4
    v_fmac_f32 v6, v5, v5
    v_lshlrev_b32 v4, 16, v23
    v_and_b32 v5, 0xffff0000, v23
    v_sub_f32 v4, v4, v2
    v_sub_f32 v5, v5, v2
    v_fmac_f32 v3, v4, v4
    v_fmac_f32 v6, v5, v5
    v_lshlrev_b32 v4, 16, v24
    v_and_b32 v5, 0xffff0000, v24
    v_sub_f32 v4, v4, v2
    v_sub_f32 v5, v5, v2
    v_fmac_f32 v3, v4, v4
    v_fmac_f32 v6, v5, v5
    v_lshlrev_b32 v4, 16, v25
    v_and_b32 v5, 0xffff0000, v25
    v_sub_f32 v4, v4, v2
    v_sub_f32 v5, v5, v2
    v_fmac_f32 v3, v4, v4
    v_fmac_f32 v6, v5, v5
    v_lshlrev_b32 v4, 16, v26
    v_and_b32 v5, 0xffff0000, v26
    v_sub_f32 v4, v4, v2
    v_sub_f32 v5, v5, v2
    v_fmac_f32 v3, v4, v4
    v_fmac_f32 v6, v5, v5
    v_lshlrev_b32 v4, 16, v27
    v_and_b32 v5, 0xffff0000, v27
    v_sub_f32 v4, v4, v2
    v_sub_f32 v5, v5, v2
    v_fmac_f32 v3, v4, v4
    v_fmac_f32 v6, v5, v5
    v_lshlrev_b32 v4, 16, v28
    v_and_b32 v5, 0xffff0000, v28
    v_sub_f32 v4, v4, v2
    v_sub_f32 v5, v5, v2
    v_fmac_f32 v3, v4, v4
    v_fmac_f32 v6, v5, v5
    v_lshlrev_b32 v4, 16, v29
    v_and_b32 v5, 0xffff0000, v29
    v_sub_f32 v4, v4, v2
    v_sub_f32 v5, v5, v2
    v_fmac_f32 v3, v4, v4
    v_fmac_f32 v6, v5, v5
    v_lshlrev_b32 v4, 16, v30
    v_and_b32 v5, 0xffff0000, v30
    v_sub_f32 v4, v4, v2
    v_sub_f32 v5, v5, v2
    v_fmac_f32 v3, v4, v4
    v_fmac_f32 v6, v5, v5
    v_lshlrev_b32 v4, 16, v31
    v_and_b32 v5, 0xffff0000, v31
    v_sub_f32 v4, v4, v2
    v_sub_f32 v5, v5, v2
    v_fmac_f32 v3, v4, v4
    v_fmac_f32 v6, v5, v5
    v_lshlrev_b32 v4, 16, v32
    v_and_b32 v5, 0xffff0000, v32
    v_sub_f32 v4, v4, v2
    v_sub_f32 v5, v5, v2
    v_fmac_f32 v3, v4, v4
    v_fmac_f32 v6, v5, v5
    v_lshlrev_b32 v4, 16, v33
    v_and_b32 v5, 0xffff0000, v33
    v_sub_f32 v4, v4, v2
    v_sub_f32 v5, v5, v2
    v_fmac_f32 v3, v4, v4
    v_fmac_f32 v6, v5, v5
    v_lshlrev_b32 v4, 16, v34
    v_and_b32 v5, 0xffff0000, v34
    v_sub_f32 v4, v4, v2
    v_sub_f32 v5, v5, v2
    v_fmac_f32 v3, v4, v4
    v_fmac_f32 v6, v5, v5
    v_lshlrev_b32 v4, 16, v35
    v_and_b32 v5, 0xffff0000, v35
    v_sub_f32 v4, v4, v2
    v_sub_f32 v5, v5, v2
    v_fmac_f32 v3, v4, v4
    v_fmac_f32 v6, v5, v5
    v_lshlrev_b32 v4, 16, v36
    v_and_b32 v5, 0xffff0000, v36
    v_sub_f32 v4, v4, v2
    v_sub_f32 v5, v5, v2
    v_fmac_f32 v3, v4, v4
    v_fmac_f32 v6, v5, v5
    v_lshlrev_b32 v4, 16, v37
    v_and_b32 v5, 0xffff0000, v37
    v_sub_f32 v4, v4, v2
    v_sub_f32 v5, v5, v2
    v_fmac_f32 v3, v4, v4
    v_fmac_f32 v6, v5, v5
    v_lshlrev_b32 v4, 16, v38
    v_and_b32 v5, 0xffff0000, v38
    v_sub_f32 v4, v4, v2
    v_sub_f32 v5, v5, v2
    v_fmac_f32 v3, v4, v4
    v_fmac_f32 v6, v5, v5
    v_lshlrev_b32 v4, 16, v39
    v_and_b32 v5, 0xffff0000, v39
    v_sub_f32 v4, v4, v2
    v_sub_f32 v5, v5, v2
    v_fmac_f32 v3, v4, v4
    v_fmac_f32 v6, v5, v5
    v_add_f32 v3, v3, v6
    s_nop 1
    v_add_f32_dpp v3, v3, v3 row_ror:8 row_mask:0xf bank_mask:0xf
    s_nop 1
    v_add_f32_dpp v3, v3, v3 row_ror:4 row_mask:0xf bank_mask:0xf
    s_nop 1
    v_add_f32_dpp v3, v3, v3 row_ror:2 row_mask:0xf bank_mask:0xf
    s_nop 1
    v_add_f32_dpp v3, v3, v3 row_ror:1 row_mask:0xf bank_mask:0xf
    v_mul_f32 v3, 0x3a800000, v3
    v_cvt_pk_bf16_f32 v2, v2, v2
    v_lshlrev_b32 v2, 16, v2
    v_cvt_pk_bf16_f32 v3, v3, v3
    v_lshlrev_b32 v3, 16, v3
    v_add_f32 v3, 0x3727c5ac, v3
    v_cvt_pk_bf16_f32 v3, v3, v3
    v_lshlrev_b32 v3, 16, v3
    v_sqrt_f32 v3, v3
    s_nop 0
    v_cvt_pk_bf16_f32 v3, v3, v3
    v_lshlrev_b32 v3, 16, v3
    v_and_b32 v4, 3, v0
    v_lshlrev_b32 v4, 6, v4
    ds_bpermute_b32 v2, v4, v2
    ds_bpermute_b32 v3, v4, v3
    s_waitcnt lgkmcnt(0)
    v_rcp_f32 v4, v3
    s_nop 0
    v_lshlrev_b32 v5, 16, v120
    v_and_b32 v6, 0xffff0000, v120
    v_sub_f32 v5, v5, v2
    v_sub_f32 v6, v6, v2
    v_cvt_pk_bf16_f32 v7, v5, v6
    v_lshlrev_b32 v5, 16, v7
    v_and_b32 v6, 0xffff0000, v7
    v_mul_f32 v136, v5, v4
    v_mul_f32 v137, v6, v4
    v_fma_f32 v5, -v136, v3, v5
    v_fma_f32 v6, -v137, v3, v6
    v_fma_f32 v136, v5, v4, v136
    v_fma_f32 v137, v6, v4, v137
    v_cvt_pk_bf16_f32 v120, v136, v137
    v_lshlrev_b32 v5, 16, v121
    v_and_b32 v6, 0xffff0000, v121
    v_sub_f32 v5, v5, v2
    v_sub_f32 v6, v6, v2
    v_cvt_pk_bf16_f32 v7, v5, v6
    v_lshlrev_b32 v5, 16, v7
    v_and_b32 v6, 0xffff0000, v7
    v_mul_f32 v136, v5, v4
    v_mul_f32 v137, v6, v4
    v_fma_f32 v5, -v136, v3, v5
    v_fma_f32 v6, -v137, v3, v6
    v_fma_f32 v136, v5, v4, v136
    v_fma_f32 v137, v6, v4, v137
    v_cvt_pk_bf16_f32 v121, v136, v137
    v_lshlrev_b32 v5, 16, v122
    v_and_b32 v6, 0xffff0000, v122
    v_sub_f32 v5, v5, v2
    v_sub_f32 v6, v6, v2
    v_cvt_pk_bf16_f32 v7, v5, v6
    v_lshlrev_b32 v5, 16, v7
    v_and_b32 v6, 0xffff0000, v7
    v_mul_f32 v136, v5, v4
    v_mul_f32 v137, v6, v4
    v_fma_f32 v5, -v136, v3, v5
    v_fma_f32 v6, -v137, v3, v6
    v_fma_f32 v136, v5, v4, v136
    v_fma_f32 v137, v6, v4, v137
    v_cvt_pk_bf16_f32 v122, v136, v137
    v_lshlrev_b32 v5, 16, v123
    v_and_b32 v6, 0xffff0000, v123
    v_sub_f32 v5, v5, v2
    v_sub_f32 v6, v6, v2
    v_cvt_pk_bf16_f32 v7, v5, v6
    v_lshlrev_b32 v5, 16, v7
    v_and_b32 v6, 0xffff0000, v7
    v_mul_f32 v136, v5, v4
    v_mul_f32 v137, v6, v4
    v_fma_f32 v5, -v136, v3, v5
    v_fma_f32 v6, -v137, v3, v6
    v_fma_f32 v136, v5, v4, v136
    v_fma_f32 v137, v6, v4, v137
    v_cvt_pk_bf16_f32 v123, v136, v137
    v_lshlrev_b32 v5, 16, v124
    v_and_b32 v6, 0xffff0000, v124
    v_sub_f32 v5, v5, v2
    v_sub_f32 v6, v6, v2
    v_cvt_pk_bf16_f32 v7, v5, v6
    v_lshlrev_b32 v5, 16, v7
    v_and_b32 v6, 0xffff0000, v7
    v_mul_f32 v136, v5, v4
    v_mul_f32 v137, v6, v4
    v_fma_f32 v5, -v136, v3, v5
    v_fma_f32 v6, -v137, v3, v6
    v_fma_f32 v136, v5, v4, v136
    v_fma_f32 v137, v6, v4, v137
    v_cvt_pk_bf16_f32 v124, v136, v137
    v_lshlrev_b32 v5, 16, v125
    v_and_b32 v6, 0xffff0000, v125
    v_sub_f32 v5, v5, v2
    v_sub_f32 v6, v6, v2
    v_cvt_pk_bf16_f32 v7, v5, v6
    v_lshlrev_b32 v5, 16, v7
    v_and_b32 v6, 0xffff0000, v7
    v_mul_f32 v136, v5, v4
    v_mul_f32 v137, v6, v4
    v_fma_f32 v5, -v136, v3, v5
    v_fma_f32 v6, -v137, v3, v6
    v_fma_f32 v136, v5, v4, v136
    v_fma_f32 v137, v6, v4, v137
    v_cvt_pk_bf16_f32 v125, v136, v137
    v_lshlrev_b32 v5, 16, v126
    v_and_b32 v6, 0xffff0000, v126
    v_sub_f32 v5, v5, v2
    v_sub_f32 v6, v6, v2
    v_cvt_pk_bf16_f32 v7, v5, v6
    v_lshlrev_b32 v5, 16, v7
    v_and_b32 v6, 0xffff0000, v7
    v_mul_f32 v136, v5, v4
    v_mul_f32 v137, v6, v4
    v_fma_f32 v5, -v136, v3, v5
    v_fma_f32 v6, -v137, v3, v6
    v_fma_f32 v136, v5, v4, v136
    v_fma_f32 v137, v6, v4, v137
    v_cvt_pk_bf16_f32 v126, v136, v137
    v_lshlrev_b32 v5, 16, v127
    v_and_b32 v6, 0xffff0000, v127
    v_sub_f32 v5, v5, v2
    v_sub_f32 v6, v6, v2
    v_cvt_pk_bf16_f32 v7, v5, v6
    v_lshlrev_b32 v5, 16, v7
    v_and_b32 v6, 0xffff0000, v7
    v_mul_f32 v136, v5, v4
    v_mul_f32 v137, v6, v4
    v_fma_f32 v5, -v136, v3, v5
    v_fma_f32 v6, -v137, v3, v6
    v_fma_f32 v136, v5, v4, v136
    v_fma_f32 v137, v6, v4, v137
    v_cvt_pk_bf16_f32 v127, v136, v137
    v_lshlrev_b32 v5, 16, v128
    v_and_b32 v6, 0xffff0000, v128
    v_sub_f32 v5, v5, v2
    v_sub_f32 v6, v6, v2
    v_cvt_pk_bf16_f32 v7, v5, v6
    v_lshlrev_b32 v5, 16, v7
    v_and_b32 v6, 0xffff0000, v7
    v_mul_f32 v136, v5, v4
    v_mul_f32 v137, v6, v4
    v_fma_f32 v5, -v136, v3, v5
    v_fma_f32 v6, -v137, v3, v6
    v_fma_f32 v136, v5, v4, v136
    v_fma_f32 v137, v6, v4, v137
    v_cvt_pk_bf16_f32 v128, v136, v137
    v_lshlrev_b32 v5, 16, v129
    v_and_b32 v6, 0xffff0000, v129
    v_sub_f32 v5, v5, v2
    v_sub_f32 v6, v6, v2
    v_cvt_pk_bf16_f32 v7, v5, v6
    v_lshlrev_b32 v5, 16, v7
    v_and_b32 v6, 0xffff0000, v7
    v_mul_f32 v136, v5, v4
    v_mul_f32 v137, v6, v4
    v_fma_f32 v5, -v136, v3, v5
    v_fma_f32 v6, -v137, v3, v6
    v_fma_f32 v136, v5, v4, v136
    v_fma_f32 v137, v6, v4, v137
    v_cvt_pk_bf16_f32 v129, v136, v137
    v_lshlrev_b32 v5, 16, v130
    v_and_b32 v6, 0xffff0000, v130
    v_sub_f32 v5, v5, v2
    v_sub_f32 v6, v6, v2
    v_cvt_pk_bf16_f32 v7, v5, v6
    v_lshlrev_b32 v5, 16, v7
    v_and_b32 v6, 0xffff0000, v7
    v_mul_f32 v136, v5, v4
    v_mul_f32 v137, v6, v4
    v_fma_f32 v5, -v136, v3, v5
    v_fma_f32 v6, -v137, v3, v6
    v_fma_f32 v136, v5, v4, v136
    v_fma_f32 v137, v6, v4, v137
    v_cvt_pk_bf16_f32 v130, v136, v137
    v_lshlrev_b32 v5, 16, v131
    v_and_b32 v6, 0xffff0000, v131
    v_sub_f32 v5, v5, v2
    v_sub_f32 v6, v6, v2
    v_cvt_pk_bf16_f32 v7, v5, v6
    v_lshlrev_b32 v5, 16, v7
    v_and_b32 v6, 0xffff0000, v7
    v_mul_f32 v136, v5, v4
    v_mul_f32 v137, v6, v4
    v_fma_f32 v5, -v136, v3, v5
    v_fma_f32 v6, -v137, v3, v6
    v_fma_f32 v136, v5, v4, v136
    v_fma_f32 v137, v6, v4, v137
    v_cvt_pk_bf16_f32 v131, v136, v137
    v_lshlrev_b32 v5, 16, v132
    v_and_b32 v6, 0xffff0000, v132
    v_sub_f32 v5, v5, v2
    v_sub_f32 v6, v6, v2
    v_cvt_pk_bf16_f32 v7, v5, v6
    v_lshlrev_b32 v5, 16, v7
    v_and_b32 v6, 0xffff0000, v7
    v_mul_f32 v136, v5, v4
    v_mul_f32 v137, v6, v4
    v_fma_f32 v5, -v136, v3, v5
    v_fma_f32 v6, -v137, v3, v6
    v_fma_f32 v136, v5, v4, v136
    v_fma_f32 v137, v6, v4, v137
    v_cvt_pk_bf16_f32 v132, v136, v137
    v_lshlrev_b32 v5, 16, v133
    v_and_b32 v6, 0xffff0000, v133
    v_sub_f32 v5, v5, v2
    v_sub_f32 v6, v6, v2
    v_cvt_pk_bf16_f32 v7, v5, v6
    v_lshlrev_b32 v5, 16, v7
    v_and_b32 v6, 0xffff0000, v7
    v_mul_f32 v136, v5, v4
    v_mul_f32 v137, v6, v4
    v_fma_f32 v5, -v136, v3, v5
    v_fma_f32 v6, -v137, v3, v6
    v_fma_f32 v136, v5, v4, v136
    v_fma_f32 v137, v6, v4, v137
    v_cvt_pk_bf16_f32 v133, v136, v137
    v_lshlrev_b32 v5, 16, v134
    v_and_b32 v6, 0xffff0000, v134
    v_sub_f32 v5, v5, v2
    v_sub_f32 v6, v6, v2
    v_cvt_pk_bf16_f32 v7, v5, v6
    v_lshlrev_b32 v5, 16, v7
    v_and_b32 v6, 0xffff0000, v7
    v_mul_f32 v136, v5, v4
    v_mul_f32 v137, v6, v4
    v_fma_f32 v5, -v136, v3, v5
    v_fma_f32 v6, -v137, v3, v6
    v_fma_f32 v136, v5, v4, v136
    v_fma_f32 v137, v6, v4, v137
    v_cvt_pk_bf16_f32 v134, v136, v137
    v_lshlrev_b32 v5, 16, v135
    v_and_b32 v6, 0xffff0000, v135
    v_sub_f32 v5, v5, v2
    v_sub_f32 v6, v6, v2
    v_cvt_pk_bf16_f32 v7, v5, v6
    v_lshlrev_b32 v5, 16, v7
    v_and_b32 v6, 0xffff0000, v7
    v_mul_f32 v136, v5, v4
    v_mul_f32 v137, v6, v4
    v_fma_f32 v5, -v136, v3, v5
    v_fma_f32 v6, -v137, v3, v6
    v_fma_f32 v136, v5, v4, v136
    v_fma_f32 v137, v6, v4, v137
    v_cvt_pk_bf16_f32 v135, v136, v137
    v_mov_b32 v1, v160
    s_waitcnt vmcnt(0)
    v_lshlrev_b32 v2, 4, v0
    v_add_u32 v3, s13, v2
    ds_read_b128 v[8:11], v3 offset:0
    ds_read_b128 v[12:15], v3 offset:1024
    ds_read_b128 v[16:19], v3 offset:2048
    ds_read_b128 v[20:23], v3 offset:3072
    ds_read_b128 v[24:27], v3 offset:4096
    ds_read_b128 v[28:31], v3 offset:5120
    ds_read_b128 v[32:35], v3 offset:6144
    ds_read_b128 v[36:39], v3 offset:7168
    ds_read_b128 v[40:43], v3 offset:8192
    ds_read_b128 v[44:47], v3 offset:9216
    ds_read_b128 v[48:51], v3 offset:10240
    ds_read_b128 v[52:55], v3 offset:11264
    ds_read_b128 v[56:59], v3 offset:12288
    ds_read_b128 v[60:63], v3 offset:13312
    ds_read_b128 v[64:67], v3 offset:14336
    ds_read_b128 v[68:71], v3 offset:15360
    s_waitcnt lgkmcnt(8)
    v_perm_b32 v104, v12, v8, s68
    v_perm_b32 v105, v20, v16, s68
    v_perm_b32 v106, v28, v24, s68
    v_perm_b32 v107, v36, v32, s68
    v_perm_b32 v108, v12, v8, s69
    v_perm_b32 v109, v20, v16, s69
    v_perm_b32 v110, v28, v24, s69
    v_perm_b32 v111, v36, v32, s69
    s_nop 1
    v_mfma_f32_16x16x32_bf16 v[72:75], v[120:123], v[104:107], 0
    v_mfma_f32_16x16x32_bf16 v[76:79], v[120:123], v[108:111], 0
    v_perm_b32 v112, v13, v9, s68
    v_perm_b32 v113, v21, v17, s68
    v_perm_b32 v114, v29, v25, s68
    v_perm_b32 v115, v37, v33, s68
    v_perm_b32 v116, v13, v9, s69
    v_perm_b32 v117, v21, v17, s69
    v_perm_b32 v118, v29, v25, s69
    v_perm_b32 v119, v37, v33, s69
    s_nop 1
    v_mfma_f32_16x16x32_bf16 v[80:83], v[120:123], v[112:115], 0
    v_mfma_f32_16x16x32_bf16 v[84:87], v[120:123], v[116:119], 0
    v_perm_b32 v104, v14, v10, s68
    v_perm_b32 v105, v22, v18, s68
    v_perm_b32 v106, v30, v26, s68
    v_perm_b32 v107, v38, v34, s68
    v_perm_b32 v108, v14, v10, s69
    v_perm_b32 v109, v22, v18, s69
    v_perm_b32 v110, v30, v26, s69
    v_perm_b32 v111, v38, v34, s69
    s_nop 1
    v_mfma_f32_16x16x32_bf16 v[88:91], v[120:123], v[104:107], 0
    v_mfma_f32_16x16x32_bf16 v[92:95], v[120:123], v[108:111], 0
    v_perm_b32 v112, v15, v11, s68
    v_perm_b32 v113, v23, v19, s68
    v_perm_b32 v114, v31, v27, s68
    v_perm_b32 v115, v39, v35, s68
    v_perm_b32 v116, v15, v11, s69
    v_perm_b32 v117, v23, v19, s69
    v_perm_b32 v118, v31, v27, s69
    v_perm_b32 v119, v39, v35, s69
    s_nop 1
    v_mfma_f32_16x16x32_bf16 v[96:99], v[120:123], v[112:115], 0
    v_mfma_f32_16x16x32_bf16 v[100:103], v[120:123], v[116:119], 0
    ds_read_b128 v[8:11], v3 offset:16384
    ds_read_b128 v[12:15], v3 offset:17408
    ds_read_b128 v[16:19], v3 offset:18432
    ds_read_b128 v[20:23], v3 offset:19456
    ds_read_b128 v[24:27], v3 offset:20480
    ds_read_b128 v[28:31], v3 offset:21504
    ds_read_b128 v[32:35], v3 offset:22528
    ds_read_b128 v[36:39], v3 offset:23552
    s_waitcnt lgkmcnt(8)
    v_perm_b32 v104, v44, v40, s68
    v_perm_b32 v105, v52, v48, s68
    v_perm_b32 v106, v60, v56, s68
    v_perm_b32 v107, v68, v64, s68
    v_perm_b32 v108, v44, v40, s69
    v_perm_b32 v109, v52, v48, s69
    v_perm_b32 v110, v60, v56, s69
    v_perm_b32 v111, v68, v64, s69
    s_nop 1
    v_mfma_f32_16x16x32_bf16 v[72:75], v[124:127], v[104:107], v[72:75]
    v_mfma_f32_16x16x32_bf16 v[76:79], v[124:127], v[108:111], v[76:79]
    v_perm_b32 v112, v45, v41, s68
    v_perm_b32 v113, v53, v49, s68
    v_perm_b32 v114, v61, v57, s68
    v_perm_b32 v115, v69, v65, s68
    v_perm_b32 v116, v45, v41, s69
    v_perm_b32 v117, v53, v49, s69
    v_perm_b32 v118, v61, v57, s69
    v_perm_b32 v119, v69, v65, s69
    s_nop 1
    v_mfma_f32_16x16x32_bf16 v[80:83], v[124:127], v[112:115], v[80:83]
    v_mfma_f32_16x16x32_bf16 v[84:87], v[124:127], v[116:119], v[84:87]
    v_perm_b32 v104, v46, v42, s68
    v_perm_b32 v105, v54, v50, s68
    v_perm_b32 v106, v62, v58, s68
    v_perm_b32 v107, v70, v66, s68
    v_perm_b32 v108, v46, v42, s69
    v_perm_b32 v109, v54, v50, s69
    v_perm_b32 v110, v62, v58, s69
    v_perm_b32 v111, v70, v66, s69
    s_nop 1
    v_mfma_f32_16x16x32_bf16 v[88:91], v[124:127], v[104:107], v[88:91]
    v_mfma_f32_16x16x32_bf16 v[92:95], v[124:127], v[108:111], v[92:95]
    v_perm_b32 v112, v47, v43, s68
    v_perm_b32 v113, v55, v51, s68
    v_perm_b32 v114, v63, v59, s68
    v_perm_b32 v115, v71, v67, s68
    v_perm_b32 v116, v47, v43, s69
    v_perm_b32 v117, v55, v51, s69
    v_perm_b32 v118, v63, v59, s69
    v_perm_b32 v119, v71, v67, s69
    s_nop 1
    v_mfma_f32_16x16x32_bf16 v[96:99], v[124:127], v[112:115], v[96:99]
    v_mfma_f32_16x16x32_bf16 v[100:103], v[124:127], v[116:119], v[100:103]
    ds_read_b128 v[40:43], v3 offset:24576
    ds_read_b128 v[44:47], v3 offset:25600
    ds_read_b128 v[48:51], v3 offset:26624
    ds_read_b128 v[52:55], v3 offset:27648
    ds_read_b128 v[56:59], v3 offset:28672
    ds_read_b128 v[60:63], v3 offset:29696
    ds_read_b128 v[64:67], v3 offset:30720
    ds_read_b128 v[68:71], v3 offset:31744
    s_waitcnt lgkmcnt(8)
    v_perm_b32 v104, v12, v8, s68
    v_perm_b32 v105, v20, v16, s68
    v_perm_b32 v106, v28, v24, s68
    v_perm_b32 v107, v36, v32, s68
    v_perm_b32 v108, v12, v8, s69
    v_perm_b32 v109, v20, v16, s69
    v_perm_b32 v110, v28, v24, s69
    v_perm_b32 v111, v36, v32, s69
    s_nop 1
    v_mfma_f32_16x16x32_bf16 v[72:75], v[128:131], v[104:107], v[72:75]
    v_mfma_f32_16x16x32_bf16 v[76:79], v[128:131], v[108:111], v[76:79]
    v_perm_b32 v112, v13, v9, s68
    v_perm_b32 v113, v21, v17, s68
    v_perm_b32 v114, v29, v25, s68
    v_perm_b32 v115, v37, v33, s68
    v_perm_b32 v116, v13, v9, s69
    v_perm_b32 v117, v21, v17, s69
    v_perm_b32 v118, v29, v25, s69
    v_perm_b32 v119, v37, v33, s69
    s_nop 1
    v_mfma_f32_16x16x32_bf16 v[80:83], v[128:131], v[112:115], v[80:83]
    v_mfma_f32_16x16x32_bf16 v[84:87], v[128:131], v[116:119], v[84:87]
    v_perm_b32 v104, v14, v10, s68
    v_perm_b32 v105, v22, v18, s68
    v_perm_b32 v106, v30, v26, s68
    v_perm_b32 v107, v38, v34, s68
    v_perm_b32 v108, v14, v10, s69
    v_perm_b32 v109, v22, v18, s69
    v_perm_b32 v110, v30, v26, s69
    v_perm_b32 v111, v38, v34, s69
    s_nop 1
    v_mfma_f32_16x16x32_bf16 v[88:91], v[128:131], v[104:107], v[88:91]
    v_mfma_f32_16x16x32_bf16 v[92:95], v[128:131], v[108:111], v[92:95]
    v_perm_b32 v112, v15, v11, s68
    v_perm_b32 v113, v23, v19, s68
    v_perm_b32 v114, v31, v27, s68
    v_perm_b32 v115, v39, v35, s68
    v_perm_b32 v116, v15, v11, s69
    v_perm_b32 v117, v23, v19, s69
    v_perm_b32 v118, v31, v27, s69
    v_perm_b32 v119, v39, v35, s69
    s_nop 1
    v_mfma_f32_16x16x32_bf16 v[96:99], v[128:131], v[112:115], v[96:99]
    v_mfma_f32_16x16x32_bf16 v[100:103], v[128:131], v[116:119], v[100:103]
    s_waitcnt lgkmcnt(0)
    v_perm_b32 v104, v44, v40, s68
    v_perm_b32 v105, v52, v48, s68
    v_perm_b32 v106, v60, v56, s68
    v_perm_b32 v107, v68, v64, s68
    v_perm_b32 v108, v44, v40, s69
    v_perm_b32 v109, v52, v48, s69
    v_perm_b32 v110, v60, v56, s69
    v_perm_b32 v111, v68, v64, s69
    s_nop 1
    v_mfma_f32_16x16x32_bf16 v[72:75], v[132:135], v[104:107], v[72:75]
    v_mfma_f32_16x16x32_bf16 v[76:79], v[132:135], v[108:111], v[76:79]
    v_perm_b32 v112, v45, v41, s68
    v_perm_b32 v113, v53, v49, s68
    v_perm_b32 v114, v61, v57, s68
    v_perm_b32 v115, v69, v65, s68
    v_perm_b32 v116, v45, v41, s69
    v_perm_b32 v117, v53, v49, s69
    v_perm_b32 v118, v61, v57, s69
    v_perm_b32 v119, v69, v65, s69
    s_nop 1
    v_mfma_f32_16x16x32_bf16 v[80:83], v[132:135], v[112:115], v[80:83]
    v_mfma_f32_16x16x32_bf16 v[84:87], v[132:135], v[116:119], v[84:87]
    v_perm_b32 v104, v46, v42, s68
    v_perm_b32 v105, v54, v50, s68
    v_perm_b32 v106, v62, v58, s68
    v_perm_b32 v107, v70, v66, s68
    v_perm_b32 v108, v46, v42, s69
    v_perm_b32 v109, v54, v50, s69
    v_perm_b32 v110, v62, v58, s69
    v_perm_b32 v111, v70, v66, s69
    s_nop 1
    v_mfma_f32_16x16x32_bf16 v[88:91], v[132:135], v[104:107], v[88:91]
    v_mfma_f32_16x16x32_bf16 v[92:95], v[132:135], v[108:111], v[92:95]
    v_perm_b32 v112, v47, v43, s68
    v_perm_b32 v113, v55, v51, s68
    v_perm_b32 v114, v63, v59, s68
    v_perm_b32 v115, v71, v67, s68
    v_perm_b32 v116, v47, v43, s69
    v_perm_b32 v117, v55, v51, s69
    v_perm_b32 v118, v63, v59, s69
    v_perm_b32 v119, v71, v67, s69
    s_nop 1
    v_mfma_f32_16x16x32_bf16 v[96:99], v[132:135], v[112:115], v[96:99]
    v_mfma_f32_16x16x32_bf16 v[100:103], v[132:135], v[116:119], v[100:103]
    s_sub_u32 s12, s3, 9
    s_mul_i32 s14, s12, 458752
    s_mul_i32 s15, s9, 57344
    s_add_u32 s14, s14, s15
    s_lshl_b32 s15, s8, 9
    s_add_u32 s14, s14, s15
    s_add_u32 s14, s14, 2097152
    s_lshl_b32 s15, s8, 4
    s_lshl_b32 s12, s12, 3
    s_add_u32 s15, s15, s12
    s_add_u32 s15, s15, s9
    s_lshl_b32 s15, s15, 2
    s_add_u32 s15, s15, 8192
    v_mov_b32 v136, s40
    v_mov_b32 v137, s40
    v_lshrrev_b32 v137, 8, v137
    v_mov_b32 v138, s40
    v_lshrrev_b32 v138, 16, v138
    v_mov_b32 v139, s40
    v_lshrrev_b32 v139, 24, v139
    s_nop 7
    v_bfi_b32 v8, s42, v136, v72
    v_bfi_b32 v9, s42, v137, v76
    v_bfi_b32 v10, s42, v138, v80
    v_bfi_b32 v11, s42, v139, v84
    v_bfi_b32 v12, s42, v136, v88
    v_bfi_b32 v13, s42, v137, v92
    v_bfi_b32 v14, s42, v138, v96
    v_bfi_b32 v15, s42, v139, v100
    v_bfi_b32 v16, s42, v136, v73
    v_bfi_b32 v17, s42, v137, v77
    v_bfi_b32 v18, s42, v138, v81
    v_bfi_b32 v19, s42, v139, v85
    v_bfi_b32 v20, s42, v136, v89
    v_bfi_b32 v21, s42, v137, v93
    v_bfi_b32 v22, s42, v138, v97
    v_bfi_b32 v23, s42, v139, v101
    v_bfi_b32 v24, s42, v136, v74
    v_bfi_b32 v25, s42, v137, v78
    v_bfi_b32 v26, s42, v138, v82
    v_bfi_b32 v27, s42, v139, v86
    v_bfi_b32 v28, s42, v136, v90
    v_bfi_b32 v29, s42, v137, v94
    v_bfi_b32 v30, s42, v138, v98
    v_bfi_b32 v31, s42, v139, v102
    v_bfi_b32 v32, s42, v136, v75
    v_bfi_b32 v33, s42, v137, v79
    v_bfi_b32 v34, s42, v138, v83
    v_bfi_b32 v35, s42, v139, v87
    v_bfi_b32 v36, s42, v136, v91
    v_bfi_b32 v37, s42, v137, v95
    v_bfi_b32 v38, s42, v138, v99
    v_bfi_b32 v39, s42, v139, v103
    v_lshlrev_b32 v2, 4, v0
    s_mov_b64 exec, 0xffff
    s_add_u32 s5, s14, 0
    buffer_store_dwordx4 v[8:11], v2, s[56:59], s5 offen sc1
    buffer_store_dwordx4 v[12:15], v2, s[56:59], s5 offen offset:256 sc1
    s_add_u32 s5, s14, 14336
    buffer_store_dwordx4 v[16:19], v2, s[56:59], s5 offen sc1
    buffer_store_dwordx4 v[20:23], v2, s[56:59], s5 offen offset:256 sc1
    s_add_u32 s5, s14, 28672
    buffer_store_dwordx4 v[24:27], v2, s[56:59], s5 offen sc1
    buffer_store_dwordx4 v[28:31], v2, s[56:59], s5 offen offset:256 sc1
    s_add_u32 s5, s14, 43008
    buffer_store_dwordx4 v[32:35], v2, s[56:59], s5 offen sc1
    buffer_store_dwordx4 v[36:39], v2, s[56:59], s5 offen offset:256 sc1
    s_mov_b64 exec, 1
    v_mov_b32 v2, 0
    s_mov_b64 exec, -1
    s_cmp_eq_u32 s3, 9
    s_cbranch_scc1 L_down
    s_endpgm
L_down:
    s_lshr_b32 s8, s97, 3
    s_and_b32 s9, s97, 7
    s_mov_b32 s52, s32
    s_mov_b32 s53, s33
    s_mov_b32 s54, 7340032
    s_mov_b32 s55, 0x00020000
    s_lshl_b32 s12, s8, 6
    s_add_u32 s12, s12, 8192
    v_lshlrev_b32 v6, 2, v0
    s_mov_b32 s41, 400000
    v_mov_b32 v3, 0
L_lw_5:
    ds_read_b32 v2, v3 offset:8
    s_waitcnt lgkmcnt(0)
    v_readfirstlane_b32 s4, v2
    s_nop 3
    s_cmp_ge_u32 s4, 8
    s_cbranch_scc1 L_lwd_6
    s_sleep 1
    s_sub_u32 s41, s41, 1
    s_cmp_lg_u32 s41, 0
    s_cbranch_scc1 L_lw_5
L_lwd_6:
    v_lshrrev_b32 v2, 4, v0
    v_mul_u32_u24 v2, 14336, v2
    v_and_b32 v3, 15, v0
    v_lshl_add_u32 v2, v3, 4, v2
    s_lshl_b32 s12, s8, 9
    s_add_u32 s12, s12, 2097152
    s_add_u32 s5, s12, 0
    buffer_load_dwordx4 v[8:11], v2, s[56:59], s5 offen
    buffer_load_dwordx4 v[12:15], v2, s[56:59], s5 offen offset:256
    s_add_u32 s5, s12, 57344
    buffer_load_dwordx4 v[16:19], v2, s[56:59], s5 offen
    buffer_load_dwordx4 v[20:23], v2, s[56:59], s5 offen offset:256
    s_add_u32 s5, s12, 114688
    buffer_load_dwordx4 v[24:27], v2, s[56:59], s5 offen
    buffer_load_dwordx4 v[28:31], v2, s[56:59], s5 offen offset:256
    s_add_u32 s5, s12, 172032
    buffer_load_dwordx4 v[32:35], v2, s[56:59], s5 offen
    buffer_load_dwordx4 v[36:39], v2, s[56:59], s5 offen offset:256
    s_add_u32 s5, s12, 229376
    buffer_load_dwordx4 v[40:43], v2, s[56:59], s5 offen
    buffer_load_dwordx4 v[44:47], v2, s[56:59], s5 offen offset:256
    s_add_u32 s5, s12, 286720
    buffer_load_dwordx4 v[48:51], v2, s[56:59], s5 offen
    buffer_load_dwordx4 v[52:55], v2, s[56:59], s5 offen offset:256
    s_add_u32 s5, s12, 344064
    buffer_load_dwordx4 v[56:59], v2, s[56:59], s5 offen
    buffer_load_dwordx4 v[60:63], v2, s[56:59], s5 offen offset:256
    s_add_u32 s5, s12, 401408
    buffer_load_dwordx4 v[64:67], v2, s[56:59], s5 offen
    buffer_load_dwordx4 v[68:71], v2, s[56:59], s5 offen offset:256
    s_add_u32 s5, s12, 458752
    buffer_load_dwordx4 v[72:75], v2, s[56:59], s5 offen
    buffer_load_dwordx4 v[76:79], v2, s[56:59], s5 offen offset:256
    s_add_u32 s5, s12, 516096
    buffer_load_dwordx4 v[80:83], v2, s[56:59], s5 offen
    buffer_load_dwordx4 v[84:87], v2, s[56:59], s5 offen offset:256
    s_add_u32 s5, s12, 573440
    buffer_load_dwordx4 v[88:91], v2, s[56:59], s5 offen
    buffer_load_dwordx4 v[92:95], v2, s[56:59], s5 offen offset:256
    s_add_u32 s5, s12, 630784
    buffer_load_dwordx4 v[96:99], v2, s[56:59], s5 offen
    buffer_load_dwordx4 v[100:103], v2, s[56:59], s5 offen offset:256
    s_add_u32 s5, s12, 688128
    buffer_load_dwordx4 v[104:107], v2, s[56:59], s5 offen
    buffer_load_dwordx4 v[108:111], v2, s[56:59], s5 offen offset:256
    s_add_u32 s5, s12, 745472
    buffer_load_dwordx4 v[112:115], v2, s[56:59], s5 offen
    buffer_load_dwordx4 v[116:119], v2, s[56:59], s5 offen offset:256
    s_add_u32 s5, s12, 802816
    buffer_load_dwordx4 v[120:123], v2, s[56:59], s5 offen
    buffer_load_dwordx4 v[124:127], v2, s[56:59], s5 offen offset:256
    s_add_u32 s5, s12, 860160
    buffer_load_dwordx4 v[128:131], v2, s[56:59], s5 offen
    buffer_load_dwordx4 v[132:135], v2, s[56:59], s5 offen offset:256
    s_waitcnt vmcnt(31)
    v_perm_b32 v137, v9, v8, s43
    v_perm_b32 v138, v11, v10, s88
    v_or_b32 v137, v137, v138
    v_xor_b32 v136, s40, v137
    s_waitcnt vmcnt(30)
    v_perm_b32 v137, v13, v12, s43
    v_perm_b32 v138, v15, v14, s88
    v_or_b32 v137, v137, v138
    v_xor_b32 v137, s40, v137
    v_or_b32 v136, v136, v137
    s_waitcnt vmcnt(29)
    v_perm_b32 v137, v17, v16, s43
    v_perm_b32 v138, v19, v18, s88
    v_or_b32 v137, v137, v138
    v_xor_b32 v137, s40, v137
    v_or_b32 v136, v136, v137
    s_waitcnt vmcnt(28)
    v_perm_b32 v137, v21, v20, s43
    v_perm_b32 v138, v23, v22, s88
    v_or_b32 v137, v137, v138
    v_xor_b32 v137, s40, v137
    v_or_b32 v136, v136, v137
    s_waitcnt vmcnt(27)
    v_perm_b32 v137, v25, v24, s43
    v_perm_b32 v138, v27, v26, s88
    v_or_b32 v137, v137, v138
    v_xor_b32 v137, s40, v137
    v_or_b32 v136, v136, v137
    s_waitcnt vmcnt(26)
    v_perm_b32 v137, v29, v28, s43
    v_perm_b32 v138, v31, v30, s88
    v_or_b32 v137, v137, v138
    v_xor_b32 v137, s40, v137
    v_or_b32 v136, v136, v137
    s_waitcnt vmcnt(25)
    v_perm_b32 v137, v33, v32, s43
    v_perm_b32 v138, v35, v34, s88
    v_or_b32 v137, v137, v138
    v_xor_b32 v137, s40, v137
    v_or_b32 v136, v136, v137
    s_waitcnt vmcnt(24)
    v_perm_b32 v137, v37, v36, s43
    v_perm_b32 v138, v39, v38, s88
    v_or_b32 v137, v137, v138
    v_xor_b32 v137, s40, v137
    v_or_b32 v136, v136, v137
    s_waitcnt vmcnt(23)
    v_perm_b32 v137, v41, v40, s43
    v_perm_b32 v138, v43, v42, s88
    v_or_b32 v137, v137, v138
    v_xor_b32 v137, s40, v137
    v_or_b32 v136, v136, v137
    s_waitcnt vmcnt(22)
    v_perm_b32 v137, v45, v44, s43
    v_perm_b32 v138, v47, v46, s88
    v_or_b32 v137, v137, v138
    v_xor_b32 v137, s40, v137
    v_or_b32 v136, v136, v137
    s_waitcnt vmcnt(21)
    v_perm_b32 v137, v49, v48, s43
    v_perm_b32 v138, v51, v50, s88
    v_or_b32 v137, v137, v138
    v_xor_b32 v137, s40, v137
    v_or_b32 v136, v136, v137
    s_waitcnt vmcnt(20)
    v_perm_b32 v137, v53, v52, s43
    v_perm_b32 v138, v55, v54, s88
    v_or_b32 v137, v137, v138
    v_xor_b32 v137, s40, v137
    v_or_b32 v136, v136, v137
    s_waitcnt vmcnt(19)
    v_perm_b32 v137, v57, v56, s43
    v_perm_b32 v138, v59, v58, s88
    v_or_b32 v137, v137, v138
    v_xor_b32 v137, s40, v137
    v_or_b32 v136, v136, v137
    s_waitcnt vmcnt(18)
    v_perm_b32 v137, v61, v60, s43
    v_perm_b32 v138, v63, v62, s88
    v_or_b32 v137, v137, v138
    v_xor_b32 v137, s40, v137
    v_or_b32 v136, v136, v137
    s_waitcnt vmcnt(17)
    v_perm_b32 v137, v65, v64, s43
    v_perm_b32 v138, v67, v66, s88
    v_or_b32 v137, v137, v138
    v_xor_b32 v137, s40, v137
    v_or_b32 v136, v136, v137
    s_waitcnt vmcnt(16)
    v_perm_b32 v137, v69, v68, s43
    v_perm_b32 v138, v71, v70, s88
    v_or_b32 v137, v137, v138
    v_xor_b32 v137, s40, v137
    v_or_b32 v136, v136, v137
    s_waitcnt vmcnt(15)
    v_perm_b32 v137, v73, v72, s43
    v_perm_b32 v138, v75, v74, s88
    v_or_b32 v137, v137, v138
    v_xor_b32 v137, s40, v137
    v_or_b32 v136, v136, v137
    s_waitcnt vmcnt(14)
    v_perm_b32 v137, v77, v76, s43
    v_perm_b32 v138, v79, v78, s88
    v_or_b32 v137, v137, v138
    v_xor_b32 v137, s40, v137
    v_or_b32 v136, v136, v137
    s_waitcnt vmcnt(13)
    v_perm_b32 v137, v81, v80, s43
    v_perm_b32 v138, v83, v82, s88
    v_or_b32 v137, v137, v138
    v_xor_b32 v137, s40, v137
    v_or_b32 v136, v136, v137
    s_waitcnt vmcnt(12)
    v_perm_b32 v137, v85, v84, s43
    v_perm_b32 v138, v87, v86, s88
    v_or_b32 v137, v137, v138
    v_xor_b32 v137, s40, v137
    v_or_b32 v136, v136, v137
    s_waitcnt vmcnt(11)
    v_perm_b32 v137, v89, v88, s43
    v_perm_b32 v138, v91, v90, s88
    v_or_b32 v137, v137, v138
    v_xor_b32 v137, s40, v137
    v_or_b32 v136, v136, v137
    s_waitcnt vmcnt(10)
    v_perm_b32 v137, v93, v92, s43
    v_perm_b32 v138, v95, v94, s88
    v_or_b32 v137, v137, v138
    v_xor_b32 v137, s40, v137
    v_or_b32 v136, v136, v137
    s_waitcnt vmcnt(9)
    v_perm_b32 v137, v97, v96, s43
    v_perm_b32 v138, v99, v98, s88
    v_or_b32 v137, v137, v138
    v_xor_b32 v137, s40, v137
    v_or_b32 v136, v136, v137
    s_waitcnt vmcnt(8)
    v_perm_b32 v137, v101, v100, s43
    v_perm_b32 v138, v103, v102, s88
    v_or_b32 v137, v137, v138
    v_xor_b32 v137, s40, v137
    v_or_b32 v136, v136, v137
    s_waitcnt vmcnt(7)
    v_perm_b32 v137, v105, v104, s43
    v_perm_b32 v138, v107, v106, s88
    v_or_b32 v137, v137, v138
    v_xor_b32 v137, s40, v137
    v_or_b32 v136, v136, v137
    s_waitcnt vmcnt(6)
    v_perm_b32 v137, v109, v108, s43
    v_perm_b32 v138, v111, v110, s88
    v_or_b32 v137, v137, v138
    v_xor_b32 v137, s40, v137
    v_or_b32 v136, v136, v137
    s_waitcnt vmcnt(5)
    v_perm_b32 v137, v113, v112, s43
    v_perm_b32 v138, v115, v114, s88
    v_or_b32 v137, v137, v138
    v_xor_b32 v137, s40, v137
    v_or_b32 v136, v136, v137
    s_waitcnt vmcnt(4)
    v_perm_b32 v137, v117, v116, s43
    v_perm_b32 v138, v119, v118, s88
    v_or_b32 v137, v137, v138
    v_xor_b32 v137, s40, v137
    v_or_b32 v136, v136, v137
    s_waitcnt vmcnt(3)
    v_perm_b32 v137, v121, v120, s43
    v_perm_b32 v138, v123, v122, s88
    v_or_b32 v137, v137, v138
    v_xor_b32 v137, s40, v137
    v_or_b32 v136, v136, v137
    s_waitcnt vmcnt(2)
    v_perm_b32 v137, v125, v124, s43
    v_perm_b32 v138, v127, v126, s88
    v_or_b32 v137, v137, v138
    v_xor_b32 v137, s40, v137
    v_or_b32 v136, v136, v137
    s_waitcnt vmcnt(1)
    v_perm_b32 v137, v129, v128, s43
    v_perm_b32 v138, v131, v130, s88
    v_or_b32 v137, v137, v138
    v_xor_b32 v137, s40, v137
    v_or_b32 v136, v136, v137
    s_waitcnt vmcnt(0)
    v_perm_b32 v137, v133, v132, s43
    v_perm_b32 v138, v135, v134, s88
    v_or_b32 v137, v137, v138
    v_xor_b32 v137, s40, v137
    v_or_b32 v136, v136, v137
    v_cmp_ne_u32 vcc, 0, v136
    s_nop 3
    s_cmp_eq_u64 vcc, 0
    s_cbranch_scc1 L_grd_8
    s_mov_b32 s41, 100000
L_gr_7:
    s_add_u32 s5, s12, 0
    buffer_load_dwordx4 v[8:11], v2, s[56:59], s5 offen sc1
    buffer_load_dwordx4 v[12:15], v2, s[56:59], s5 offen offset:256 sc1
    s_add_u32 s5, s12, 57344
    buffer_load_dwordx4 v[16:19], v2, s[56:59], s5 offen sc1
    buffer_load_dwordx4 v[20:23], v2, s[56:59], s5 offen offset:256 sc1
    s_add_u32 s5, s12, 114688
    buffer_load_dwordx4 v[24:27], v2, s[56:59], s5 offen sc1
    buffer_load_dwordx4 v[28:31], v2, s[56:59], s5 offen offset:256 sc1
    s_add_u32 s5, s12, 172032
    buffer_load_dwordx4 v[32:35], v2, s[56:59], s5 offen sc1
    buffer_load_dwordx4 v[36:39], v2, s[56:59], s5 offen offset:256 sc1
    s_add_u32 s5, s12, 229376
    buffer_load_dwordx4 v[40:43], v2, s[56:59], s5 offen sc1
    buffer_load_dwordx4 v[44:47], v2, s[56:59], s5 offen offset:256 sc1
    s_add_u32 s5, s12, 286720
    buffer_load_dwordx4 v[48:51], v2, s[56:59], s5 offen sc1
    buffer_load_dwordx4 v[52:55], v2, s[56:59], s5 offen offset:256 sc1
    s_add_u32 s5, s12, 344064
    buffer_load_dwordx4 v[56:59], v2, s[56:59], s5 offen sc1
    buffer_load_dwordx4 v[60:63], v2, s[56:59], s5 offen offset:256 sc1
    s_add_u32 s5, s12, 401408
    buffer_load_dwordx4 v[64:67], v2, s[56:59], s5 offen sc1
    buffer_load_dwordx4 v[68:71], v2, s[56:59], s5 offen offset:256 sc1
    s_add_u32 s5, s12, 458752
    buffer_load_dwordx4 v[72:75], v2, s[56:59], s5 offen sc1
    buffer_load_dwordx4 v[76:79], v2, s[56:59], s5 offen offset:256 sc1
    s_add_u32 s5, s12, 516096
    buffer_load_dwordx4 v[80:83], v2, s[56:59], s5 offen sc1
    buffer_load_dwordx4 v[84:87], v2, s[56:59], s5 offen offset:256 sc1
    s_add_u32 s5, s12, 573440
    buffer_load_dwordx4 v[88:91], v2, s[56:59], s5 offen sc1
    buffer_load_dwordx4 v[92:95], v2, s[56:59], s5 offen offset:256 sc1
    s_add_u32 s5, s12, 630784
    buffer_load_dwordx4 v[96:99], v2, s[56:59], s5 offen sc1
    buffer_load_dwordx4 v[100:103], v2, s[56:59], s5 offen offset:256 sc1
    s_add_u32 s5, s12, 688128
    buffer_load_dwordx4 v[104:107], v2, s[56:59], s5 offen sc1
    buffer_load_dwordx4 v[108:111], v2, s[56:59], s5 offen offset:256 sc1
    s_add_u32 s5, s12, 745472
    buffer_load_dwordx4 v[112:115], v2, s[56:59], s5 offen sc1
    buffer_load_dwordx4 v[116:119], v2, s[56:59], s5 offen offset:256 sc1
    s_add_u32 s5, s12, 802816
    buffer_load_dwordx4 v[120:123], v2, s[56:59], s5 offen sc1
    buffer_load_dwordx4 v[124:127], v2, s[56:59], s5 offen offset:256 sc1
    s_add_u32 s5, s12, 860160
    buffer_load_dwordx4 v[128:131], v2, s[56:59], s5 offen sc1
    buffer_load_dwordx4 v[132:135], v2, s[56:59], s5 offen offset:256 sc1
    s_waitcnt vmcnt(31)
    v_perm_b32 v137, v9, v8, s43
    v_perm_b32 v138, v11, v10, s88
    v_or_b32 v137, v137, v138
    v_xor_b32 v136, s40, v137
    s_waitcnt vmcnt(30)
    v_perm_b32 v137, v13, v12, s43
    v_perm_b32 v138, v15, v14, s88
    v_or_b32 v137, v137, v138
    v_xor_b32 v137, s40, v137
    v_or_b32 v136, v136, v137
    s_waitcnt vmcnt(29)
    v_perm_b32 v137, v17, v16, s43
    v_perm_b32 v138, v19, v18, s88
    v_or_b32 v137, v137, v138
    v_xor_b32 v137, s40, v137
    v_or_b32 v136, v136, v137
    s_waitcnt vmcnt(28)
    v_perm_b32 v137, v21, v20, s43
    v_perm_b32 v138, v23, v22, s88
    v_or_b32 v137, v137, v138
    v_xor_b32 v137, s40, v137
    v_or_b32 v136, v136, v137
    s_waitcnt vmcnt(27)
    v_perm_b32 v137, v25, v24, s43
    v_perm_b32 v138, v27, v26, s88
    v_or_b32 v137, v137, v138
    v_xor_b32 v137, s40, v137
    v_or_b32 v136, v136, v137
    s_waitcnt vmcnt(26)
    v_perm_b32 v137, v29, v28, s43
    v_perm_b32 v138, v31, v30, s88
    v_or_b32 v137, v137, v138
    v_xor_b32 v137, s40, v137
    v_or_b32 v136, v136, v137
    s_waitcnt vmcnt(25)
    v_perm_b32 v137, v33, v32, s43
    v_perm_b32 v138, v35, v34, s88
    v_or_b32 v137, v137, v138
    v_xor_b32 v137, s40, v137
    v_or_b32 v136, v136, v137
    s_waitcnt vmcnt(24)
    v_perm_b32 v137, v37, v36, s43
    v_perm_b32 v138, v39, v38, s88
    v_or_b32 v137, v137, v138
    v_xor_b32 v137, s40, v137
    v_or_b32 v136, v136, v137
    s_waitcnt vmcnt(23)
    v_perm_b32 v137, v41, v40, s43
    v_perm_b32 v138, v43, v42, s88
    v_or_b32 v137, v137, v138
    v_xor_b32 v137, s40, v137
    v_or_b32 v136, v136, v137
    s_waitcnt vmcnt(22)
    v_perm_b32 v137, v45, v44, s43
    v_perm_b32 v138, v47, v46, s88
    v_or_b32 v137, v137, v138
    v_xor_b32 v137, s40, v137
    v_or_b32 v136, v136, v137
    s_waitcnt vmcnt(21)
    v_perm_b32 v137, v49, v48, s43
    v_perm_b32 v138, v51, v50, s88
    v_or_b32 v137, v137, v138
    v_xor_b32 v137, s40, v137
    v_or_b32 v136, v136, v137
    s_waitcnt vmcnt(20)
    v_perm_b32 v137, v53, v52, s43
    v_perm_b32 v138, v55, v54, s88
    v_or_b32 v137, v137, v138
    v_xor_b32 v137, s40, v137
    v_or_b32 v136, v136, v137
    s_waitcnt vmcnt(19)
    v_perm_b32 v137, v57, v56, s43
    v_perm_b32 v138, v59, v58, s88
    v_or_b32 v137, v137, v138
    v_xor_b32 v137, s40, v137
    v_or_b32 v136, v136, v137
    s_waitcnt vmcnt(18)
    v_perm_b32 v137, v61, v60, s43
    v_perm_b32 v138, v63, v62, s88
    v_or_b32 v137, v137, v138
    v_xor_b32 v137, s40, v137
    v_or_b32 v136, v136, v137
    s_waitcnt vmcnt(17)
    v_perm_b32 v137, v65, v64, s43
    v_perm_b32 v138, v67, v66, s88
    v_or_b32 v137, v137, v138
    v_xor_b32 v137, s40, v137
    v_or_b32 v136, v136, v137
    s_waitcnt vmcnt(16)
    v_perm_b32 v137, v69, v68, s43
    v_perm_b32 v138, v71, v70, s88
    v_or_b32 v137, v137, v138
    v_xor_b32 v137, s40, v137
    v_or_b32 v136, v136, v137
    s_waitcnt vmcnt(15)
    v_perm_b32 v137, v73, v72, s43
    v_perm_b32 v138, v75, v74, s88
    v_or_b32 v137, v137, v138
    v_xor_b32 v137, s40, v137
    v_or_b32 v136, v136, v137
    s_waitcnt vmcnt(14)
    v_perm_b32 v137, v77, v76, s43
    v_perm_b32 v138, v79, v78, s88
    v_or_b32 v137, v137, v138
    v_xor_b32 v137, s40, v137
    v_or_b32 v136, v136, v137
    s_waitcnt vmcnt(13)
    v_perm_b32 v137, v81, v80, s43
    v_perm_b32 v138, v83, v82, s88
    v_or_b32 v137, v137, v138
    v_xor_b32 v137, s40, v137
    v_or_b32 v136, v136, v137
    s_waitcnt vmcnt(12)
    v_perm_b32 v137, v85, v84, s43
    v_perm_b32 v138, v87, v86, s88
    v_or_b32 v137, v137, v138
    v_xor_b32 v137, s40, v137
    v_or_b32 v136, v136, v137
    s_waitcnt vmcnt(11)
    v_perm_b32 v137, v89, v88, s43
    v_perm_b32 v138, v91, v90, s88
    v_or_b32 v137, v137, v138
    v_xor_b32 v137, s40, v137
    v_or_b32 v136, v136, v137
    s_waitcnt vmcnt(10)
    v_perm_b32 v137, v93, v92, s43
    v_perm_b32 v138, v95, v94, s88
    v_or_b32 v137, v137, v138
    v_xor_b32 v137, s40, v137
    v_or_b32 v136, v136, v137
    s_waitcnt vmcnt(9)
    v_perm_b32 v137, v97, v96, s43
    v_perm_b32 v138, v99, v98, s88
    v_or_b32 v137, v137, v138
    v_xor_b32 v137, s40, v137
    v_or_b32 v136, v136, v137
    s_waitcnt vmcnt(8)
    v_perm_b32 v137, v101, v100, s43
    v_perm_b32 v138, v103, v102, s88
    v_or_b32 v137, v137, v138
    v_xor_b32 v137, s40, v137
    v_or_b32 v136, v136, v137
    s_waitcnt vmcnt(7)
    v_perm_b32 v137, v105, v104, s43
    v_perm_b32 v138, v107, v106, s88
    v_or_b32 v137, v137, v138
    v_xor_b32 v137, s40, v137
    v_or_b32 v136, v136, v137
    s_waitcnt vmcnt(6)
    v_perm_b32 v137, v109, v108, s43
    v_perm_b32 v138, v111, v110, s88
    v_or_b32 v137, v137, v138
    v_xor_b32 v137, s40, v137
    v_or_b32 v136, v136, v137
    s_waitcnt vmcnt(5)
    v_perm_b32 v137, v113, v112, s43
    v_perm_b32 v138, v115, v114, s88
    v_or_b32 v137, v137, v138
    v_xor_b32 v137, s40, v137
    v_or_b32 v136, v136, v137
    s_waitcnt vmcnt(4)
    v_perm_b32 v137, v117, v116, s43
    v_perm_b32 v138, v119, v118, s88
    v_or_b32 v137, v137, v138
    v_xor_b32 v137, s40, v137
    v_or_b32 v136, v136, v137
    s_waitcnt vmcnt(3)
    v_perm_b32 v137, v121, v120, s43
    v_perm_b32 v138, v123, v122, s88
    v_or_b32 v137, v137, v138
    v_xor_b32 v137, s40, v137
    v_or_b32 v136, v136, v137
    s_waitcnt vmcnt(2)
    v_perm_b32 v137, v125, v124, s43
    v_perm_b32 v138, v127, v126, s88
    v_or_b32 v137, v137, v138
    v_xor_b32 v137, s40, v137
    v_or_b32 v136, v136, v137
    s_waitcnt vmcnt(1)
    v_perm_b32 v137, v129, v128, s43
    v_perm_b32 v138, v131, v130, s88
    v_or_b32 v137, v137, v138
    v_xor_b32 v137, s40, v137
    v_or_b32 v136, v136, v137
    s_waitcnt vmcnt(0)
    v_perm_b32 v137, v133, v132, s43
    v_perm_b32 v138, v135, v134, s88
    v_or_b32 v137, v137, v138
    v_xor_b32 v137, s40, v137
    v_or_b32 v136, v136, v137
    v_cmp_ne_u32 vcc, 0, v136
    s_nop 3
    s_cmp_eq_u64 vcc, 0
    s_cbranch_scc1 L_grd_8
    s_sleep 2
    s_sub_u32 s41, s41, 1
    s_cmp_lg_u32 s41, 0
    s_cbranch_scc1 L_gr_7
L_grd_8:
    v_add_f32 v8, v8, v16
    v_add_f32 v9, v9, v17
    v_add_f32 v10, v10, v18
    v_add_f32 v11, v11, v19
    v_add_f32 v12, v12, v20
    v_add_f32 v13, v13, v21
    v_add_f32 v14, v14, v22
    v_add_f32 v15, v15, v23
    v_add_f32 v8, v8, v24
    v_add_f32 v9, v9, v25
    v_add_f32 v10, v10, v26
    v_add_f32 v11, v11, v27
    v_add_f32 v12, v12, v28
    v_add_f32 v13, v13, v29
    v_add_f32 v14, v14, v30
    v_add_f32 v15, v15, v31
    v_add_f32 v8, v8, v32
    v_add_f32 v9, v9, v33
    v_add_f32 v10, v10, v34
    v_add_f32 v11, v11, v35
    v_add_f32 v12, v12, v36
    v_add_f32 v13, v13, v37
    v_add_f32 v14, v14, v38
    v_add_f32 v15, v15, v39
    v_add_f32 v8, v8, v40
    v_add_f32 v9, v9, v41
    v_add_f32 v10, v10, v42
    v_add_f32 v11, v11, v43
    v_add_f32 v12, v12, v44
    v_add_f32 v13, v13, v45
    v_add_f32 v14, v14, v46
    v_add_f32 v15, v15, v47
    v_add_f32 v8, v8, v48
    v_add_f32 v9, v9, v49
    v_add_f32 v10, v10, v50
    v_add_f32 v11, v11, v51
    v_add_f32 v12, v12, v52
    v_add_f32 v13, v13, v53
    v_add_f32 v14, v14, v54
    v_add_f32 v15, v15, v55
    v_add_f32 v8, v8, v56
    v_add_f32 v9, v9, v57
    v_add_f32 v10, v10, v58
    v_add_f32 v11, v11, v59
    v_add_f32 v12, v12, v60
    v_add_f32 v13, v13, v61
    v_add_f32 v14, v14, v62
    v_add_f32 v15, v15, v63
    v_add_f32 v8, v8, v64
    v_add_f32 v9, v9, v65
    v_add_f32 v10, v10, v66
    v_add_f32 v11, v11, v67
    v_add_f32 v12, v12, v68
    v_add_f32 v13, v13, v69
    v_add_f32 v14, v14, v70
    v_add_f32 v15, v15, v71
    v_add_f32 v72, v72, v80
    v_add_f32 v73, v73, v81
    v_add_f32 v74, v74, v82
    v_add_f32 v75, v75, v83
    v_add_f32 v76, v76, v84
    v_add_f32 v77, v77, v85
    v_add_f32 v78, v78, v86
    v_add_f32 v79, v79, v87
    v_add_f32 v72, v72, v88
    v_add_f32 v73, v73, v89
    v_add_f32 v74, v74, v90
    v_add_f32 v75, v75, v91
    v_add_f32 v76, v76, v92
    v_add_f32 v77, v77, v93
    v_add_f32 v78, v78, v94
    v_add_f32 v79, v79, v95
    v_add_f32 v72, v72, v96
    v_add_f32 v73, v73, v97
    v_add_f32 v74, v74, v98
    v_add_f32 v75, v75, v99
    v_add_f32 v76, v76, v100
    v_add_f32 v77, v77, v101
    v_add_f32 v78, v78, v102
    v_add_f32 v79, v79, v103
    v_add_f32 v72, v72, v104
    v_add_f32 v73, v73, v105
    v_add_f32 v74, v74, v106
    v_add_f32 v75, v75, v107
    v_add_f32 v76, v76, v108
    v_add_f32 v77, v77, v109
    v_add_f32 v78, v78, v110
    v_add_f32 v79, v79, v111
    v_add_f32 v72, v72, v112
    v_add_f32 v73, v73, v113
    v_add_f32 v74, v74, v114
    v_add_f32 v75, v75, v115
    v_add_f32 v76, v76, v116
    v_add_f32 v77, v77, v117
    v_add_f32 v78, v78, v118
    v_add_f32 v79, v79, v119
    v_add_f32 v72, v72, v120
    v_add_f32 v73, v73, v121
    v_add_f32 v74, v74, v122
    v_add_f32 v75, v75, v123
    v_add_f32 v76, v76, v124
    v_add_f32 v77, v77, v125
    v_add_f32 v78, v78, v126
    v_add_f32 v79, v79, v127
    v_add_f32 v72, v72, v128
    v_add_f32 v73, v73, v129
    v_add_f32 v74, v74, v130
    v_add_f32 v75, v75, v131
    v_add_f32 v76, v76, v132
    v_add_f32 v77, v77, v133
    v_add_f32 v78, v78, v134
    v_add_f32 v79, v79, v135
    s_mov_b32 s12, 0x3d372713
    s_mov_b32 s13, 0xc0135761
    v_cvt_pk_bf16_f32 v8, v8, v8
    v_lshlrev_b32 v8, 16, v8
    v_cvt_pk_bf16_f32 v72, v72, v72
    v_lshlrev_b32 v72, 16, v72
    v_mul_f32 v16, v8, v8
    v_mul_f32 v16, v16, v8
    v_fma_f32 v16, v16, s12, v8
    v_mul_f32 v16, s13, v16
    v_exp_f32 v16, v16
    s_nop 0
    v_add_f32 v16, 1.0, v16
    v_rcp_f32 v16, v16
    s_nop 0
    v_mul_f32 v16, v16, v8
    v_cvt_pk_bf16_f32 v16, v16, v16
    v_lshlrev_b32 v16, 16, v16
    v_mul_f32 v16, v16, v72
    v_cvt_pk_bf16_f32 v9, v9, v9
    v_lshlrev_b32 v9, 16, v9
    v_cvt_pk_bf16_f32 v73, v73, v73
    v_lshlrev_b32 v73, 16, v73
    v_mul_f32 v17, v9, v9
    v_mul_f32 v17, v17, v9
    v_fma_f32 v17, v17, s12, v9
    v_mul_f32 v17, s13, v17
    v_exp_f32 v17, v17
    s_nop 0
    v_add_f32 v17, 1.0, v17
    v_rcp_f32 v17, v17
    s_nop 0
    v_mul_f32 v17, v17, v9
    v_cvt_pk_bf16_f32 v17, v17, v17
    v_lshlrev_b32 v17, 16, v17
    v_mul_f32 v17, v17, v73
    v_cvt_pk_bf16_f32 v10, v10, v10
    v_lshlrev_b32 v10, 16, v10
    v_cvt_pk_bf16_f32 v74, v74, v74
    v_lshlrev_b32 v74, 16, v74
    v_mul_f32 v18, v10, v10
    v_mul_f32 v18, v18, v10
    v_fma_f32 v18, v18, s12, v10
    v_mul_f32 v18, s13, v18
    v_exp_f32 v18, v18
    s_nop 0
    v_add_f32 v18, 1.0, v18
    v_rcp_f32 v18, v18
    s_nop 0
    v_mul_f32 v18, v18, v10
    v_cvt_pk_bf16_f32 v18, v18, v18
    v_lshlrev_b32 v18, 16, v18
    v_mul_f32 v18, v18, v74
    v_cvt_pk_bf16_f32 v11, v11, v11
    v_lshlrev_b32 v11, 16, v11
    v_cvt_pk_bf16_f32 v75, v75, v75
    v_lshlrev_b32 v75, 16, v75
    v_mul_f32 v19, v11, v11
    v_mul_f32 v19, v19, v11
    v_fma_f32 v19, v19, s12, v11
    v_mul_f32 v19, s13, v19
    v_exp_f32 v19, v19
    s_nop 0
    v_add_f32 v19, 1.0, v19
    v_rcp_f32 v19, v19
    s_nop 0
    v_mul_f32 v19, v19, v11
    v_cvt_pk_bf16_f32 v19, v19, v19
    v_lshlrev_b32 v19, 16, v19
    v_mul_f32 v19, v19, v75
    v_cvt_pk_bf16_f32 v12, v12, v12
    v_lshlrev_b32 v12, 16, v12
    v_cvt_pk_bf16_f32 v76, v76, v76
    v_lshlrev_b32 v76, 16, v76
    v_mul_f32 v20, v12, v12
    v_mul_f32 v20, v20, v12
    v_fma_f32 v20, v20, s12, v12
    v_mul_f32 v20, s13, v20
    v_exp_f32 v20, v20
    s_nop 0
    v_add_f32 v20, 1.0, v20
    v_rcp_f32 v20, v20
    s_nop 0
    v_mul_f32 v20, v20, v12
    v_cvt_pk_bf16_f32 v20, v20, v20
    v_lshlrev_b32 v20, 16, v20
    v_mul_f32 v20, v20, v76
    v_cvt_pk_bf16_f32 v13, v13, v13
    v_lshlrev_b32 v13, 16, v13
    v_cvt_pk_bf16_f32 v77, v77, v77
    v_lshlrev_b32 v77, 16, v77
    v_mul_f32 v21, v13, v13
    v_mul_f32 v21, v21, v13
    v_fma_f32 v21, v21, s12, v13
    v_mul_f32 v21, s13, v21
    v_exp_f32 v21, v21
    s_nop 0
    v_add_f32 v21, 1.0, v21
    v_rcp_f32 v21, v21
    s_nop 0
    v_mul_f32 v21, v21, v13
    v_cvt_pk_bf16_f32 v21, v21, v21
    v_lshlrev_b32 v21, 16, v21
    v_mul_f32 v21, v21, v77
    v_cvt_pk_bf16_f32 v14, v14, v14
    v_lshlrev_b32 v14, 16, v14
    v_cvt_pk_bf16_f32 v78, v78, v78
    v_lshlrev_b32 v78, 16, v78
    v_mul_f32 v22, v14, v14
    v_mul_f32 v22, v22, v14
    v_fma_f32 v22, v22, s12, v14
    v_mul_f32 v22, s13, v22
    v_exp_f32 v22, v22
    s_nop 0
    v_add_f32 v22, 1.0, v22
    v_rcp_f32 v22, v22
    s_nop 0
    v_mul_f32 v22, v22, v14
    v_cvt_pk_bf16_f32 v22, v22, v22
    v_lshlrev_b32 v22, 16, v22
    v_mul_f32 v22, v22, v78
    v_cvt_pk_bf16_f32 v15, v15, v15
    v_lshlrev_b32 v15, 16, v15
    v_cvt_pk_bf16_f32 v79, v79, v79
    v_lshlrev_b32 v79, 16, v79
    v_mul_f32 v23, v15, v15
    v_mul_f32 v23, v23, v15
    v_fma_f32 v23, v23, s12, v15
    v_mul_f32 v23, s13, v23
    v_exp_f32 v23, v23
    s_nop 0
    v_add_f32 v23, 1.0, v23
    v_rcp_f32 v23, v23
    s_nop 0
    v_mul_f32 v23, v23, v15
    v_cvt_pk_bf16_f32 v23, v23, v23
    v_lshlrev_b32 v23, 16, v23
    v_mul_f32 v23, v23, v79
    v_cvt_pk_bf16_f32 v24, v16, v17
    v_cvt_pk_bf16_f32 v25, v18, v19
    v_cvt_pk_bf16_f32 v26, v20, v21
    v_cvt_pk_bf16_f32 v27, v22, v23
    v_lshlrev_b32 v2, 4, v0
    ds_write_b128 v2, v[24:27] offset:4096
    v_and_b32 v2, 3, v0
    v_lshlrev_b32 v2, 8, v2
    v_lshrrev_b32 v3, 4, v0
    v_lshlrev_b32 v3, 4, v3
    v_add_u32 v2, v2, v3
    s_waitcnt lgkmcnt(0)
    ds_read_b128 v[120:123], v2 offset:4096
    ds_read_b128 v[124:127], v2 offset:4160
    ds_read_b128 v[128:131], v2 offset:4224
    ds_read_b128 v[132:135], v2 offset:4288
    s_waitcnt lgkmcnt(0)
    v_lshrrev_b32 v2, 4, v0
    s_mov_b32 s5, 16384
    v_mul_lo_u32 v2, v2, s5
    v_and_b32 v1, 15, v0
    v_lshlrev_b32 v1, 4, v1
    v_add_u32 v1, v1, v2
    s_mov_b32 s41, 400000
    v_mov_b32 v3, 0
L_lw_9:
    ds_read_b32 v2, v3 offset:16
    s_waitcnt lgkmcnt(0)
    v_readfirstlane_b32 s4, v2
    s_nop 3
    s_cmp_ge_u32 s4, 1
    s_cbranch_scc1 L_lwd_10
    s_sleep 1
    s_sub_u32 s41, s41, 1
    s_cmp_lg_u32 s41, 0
    s_cbranch_scc1 L_lw_9
L_lwd_10:
    s_mul_i32 s11, s8, 262144
    s_lshl_b32 s12, s9, 8
    s_add_u32 s11, s11, s12
    s_add_u32 s5, s11, 0
    s_mov_b32 m0, 73728
    s_nop 0
    buffer_load_dwordx4 v1, s[52:55], s5 offen nt lds
    s_add_u32 s5, s11, 2048
    s_mov_b32 m0, 74752
    s_nop 0
    buffer_load_dwordx4 v1, s[52:55], s5 offen nt lds
    s_add_u32 s5, s11, 4096
    s_mov_b32 m0, 75776
    s_nop 0
    buffer_load_dwordx4 v1, s[52:55], s5 offen nt lds
    s_add_u32 s5, s11, 6144
    s_mov_b32 m0, 76800
    s_nop 0
    buffer_load_dwordx4 v1, s[52:55], s5 offen nt lds
    s_add_u32 s5, s11, 8192
    s_mov_b32 m0, 77824
    s_nop 0
    buffer_load_dwordx4 v1, s[52:55], s5 offen nt lds
    s_add_u32 s5, s11, 10240
    s_mov_b32 m0, 78848
    s_nop 0
    buffer_load_dwordx4 v1, s[52:55], s5 offen nt lds
    s_add_u32 s5, s11, 12288
    s_mov_b32 m0, 79872
    s_nop 0
    buffer_load_dwordx4 v1, s[52:55], s5 offen nt lds
    s_add_u32 s5, s11, 14336
    s_mov_b32 m0, 80896
    s_nop 0
    buffer_load_dwordx4 v1, s[52:55], s5 offen nt lds
    s_add_u32 s5, s11, 65536
    s_mov_b32 m0, 81920
    s_nop 0
    buffer_load_dwordx4 v1, s[52:55], s5 offen nt lds
    s_add_u32 s5, s11, 67584
    s_mov_b32 m0, 82944
    s_nop 0
    buffer_load_dwordx4 v1, s[52:55], s5 offen nt lds
    s_add_u32 s5, s11, 69632
    s_mov_b32 m0, 83968
    s_nop 0
    buffer_load_dwordx4 v1, s[52:55], s5 offen nt lds
    s_add_u32 s5, s11, 71680
    s_mov_b32 m0, 84992
    s_nop 0
    buffer_load_dwordx4 v1, s[52:55], s5 offen nt lds
    s_add_u32 s5, s11, 73728
    s_mov_b32 m0, 86016
    s_nop 0
    buffer_load_dwordx4 v1, s[52:55], s5 offen nt lds
    s_add_u32 s5, s11, 75776
    s_mov_b32 m0, 87040
    s_nop 0
    buffer_load_dwordx4 v1, s[52:55], s5 offen nt lds
    s_add_u32 s5, s11, 77824
    s_mov_b32 m0, 88064
    s_nop 0
    buffer_load_dwordx4 v1, s[52:55], s5 offen nt lds
    s_add_u32 s5, s11, 79872
    s_mov_b32 m0, 89088
    s_nop 0
    buffer_load_dwordx4 v1, s[52:55], s5 offen nt lds
    s_add_u32 s5, s11, 131072
    s_mov_b32 m0, 90112
    s_nop 0
    buffer_load_dwordx4 v1, s[52:55], s5 offen nt lds
    s_add_u32 s5, s11, 133120
    s_mov_b32 m0, 91136
    s_nop 0
    buffer_load_dwordx4 v1, s[52:55], s5 offen nt lds
    s_add_u32 s5, s11, 135168
    s_mov_b32 m0, 92160
    s_nop 0
    buffer_load_dwordx4 v1, s[52:55], s5 offen nt lds
    s_add_u32 s5, s11, 137216
    s_mov_b32 m0, 93184
    s_nop 0
    buffer_load_dwordx4 v1, s[52:55], s5 offen nt lds
    s_add_u32 s5, s11, 139264
    s_mov_b32 m0, 94208
    s_nop 0
    buffer_load_dwordx4 v1, s[52:55], s5 offen nt lds
    s_add_u32 s5, s11, 141312
    s_mov_b32 m0, 95232
    s_nop 0
    buffer_load_dwordx4 v1, s[52:55], s5 offen nt lds
    s_add_u32 s5, s11, 143360
    s_mov_b32 m0, 96256
    s_nop 0
    buffer_load_dwordx4 v1, s[52:55], s5 offen nt lds
    s_add_u32 s5, s11, 145408
    s_mov_b32 m0, 97280
    s_nop 0
    buffer_load_dwordx4 v1, s[52:55], s5 offen nt lds
    s_add_u32 s5, s11, 196608
    s_mov_b32 m0, 98304
    s_nop 0
    buffer_load_dwordx4 v1, s[52:55], s5 offen nt lds
    s_add_u32 s5, s11, 198656
    s_mov_b32 m0, 99328
    s_nop 0
    buffer_load_dwordx4 v1, s[52:55], s5 offen nt lds
    s_add_u32 s5, s11, 200704
    s_mov_b32 m0, 100352
    s_nop 0
    buffer_load_dwordx4 v1, s[52:55], s5 offen nt lds
    s_add_u32 s5, s11, 202752
    s_mov_b32 m0, 101376
    s_nop 0
    buffer_load_dwordx4 v1, s[52:55], s5 offen nt lds
    s_add_u32 s5, s11, 204800
    s_mov_b32 m0, 102400
    s_nop 0
    buffer_load_dwordx4 v1, s[52:55], s5 offen nt lds
    s_add_u32 s5, s11, 206848
    s_mov_b32 m0, 103424
    s_nop 0
    buffer_load_dwordx4 v1, s[52:55], s5 offen nt lds
    s_add_u32 s5, s11, 208896
    s_mov_b32 m0, 104448
    s_nop 0
    buffer_load_dwordx4 v1, s[52:55], s5 offen nt lds
    s_add_u32 s5, s11, 210944
    s_mov_b32 m0, 105472
    s_nop 0
    buffer_load_dwordx4 v1, s[52:55], s5 offen nt lds
    s_waitcnt vmcnt(0)
    v_lshlrev_b32 v2, 4, v0
    v_add_u32 v3, 73728, v2
    ds_read_b128 v[8:11], v3 offset:0
    ds_read_b128 v[12:15], v3 offset:1024
    ds_read_b128 v[16:19], v3 offset:2048
    ds_read_b128 v[20:23], v3 offset:3072
    ds_read_b128 v[24:27], v3 offset:4096
    ds_read_b128 v[28:31], v3 offset:5120
    ds_read_b128 v[32:35], v3 offset:6144
    ds_read_b128 v[36:39], v3 offset:7168
    ds_read_b128 v[40:43], v3 offset:8192
    ds_read_b128 v[44:47], v3 offset:9216
    ds_read_b128 v[48:51], v3 offset:10240
    ds_read_b128 v[52:55], v3 offset:11264
    ds_read_b128 v[56:59], v3 offset:12288
    ds_read_b128 v[60:63], v3 offset:13312
    ds_read_b128 v[64:67], v3 offset:14336
    ds_read_b128 v[68:71], v3 offset:15360
    s_waitcnt lgkmcnt(8)
    v_perm_b32 v104, v12, v8, s68
    v_perm_b32 v105, v20, v16, s68
    v_perm_b32 v106, v28, v24, s68
    v_perm_b32 v107, v36, v32, s68
    v_perm_b32 v108, v12, v8, s69
    v_perm_b32 v109, v20, v16, s69
    v_perm_b32 v110, v28, v24, s69
    v_perm_b32 v111, v36, v32, s69
    s_nop 1
    v_mfma_f32_16x16x32_bf16 v[72:75], v[120:123], v[104:107], 0
    v_mfma_f32_16x16x32_bf16 v[76:79], v[120:123], v[108:111], 0
    v_perm_b32 v112, v13, v9, s68
    v_perm_b32 v113, v21, v17, s68
    v_perm_b32 v114, v29, v25, s68
    v_perm_b32 v115, v37, v33, s68
    v_perm_b32 v116, v13, v9, s69
    v_perm_b32 v117, v21, v17, s69
    v_perm_b32 v118, v29, v25, s69
    v_perm_b32 v119, v37, v33, s69
    s_nop 1
    v_mfma_f32_16x16x32_bf16 v[80:83], v[120:123], v[112:115], 0
    v_mfma_f32_16x16x32_bf16 v[84:87], v[120:123], v[116:119], 0
    v_perm_b32 v104, v14, v10, s68
    v_perm_b32 v105, v22, v18, s68
    v_perm_b32 v106, v30, v26, s68
    v_perm_b32 v107, v38, v34, s68
    v_perm_b32 v108, v14, v10, s69
    v_perm_b32 v109, v22, v18, s69
    v_perm_b32 v110, v30, v26, s69
    v_perm_b32 v111, v38, v34, s69
    s_nop 1
    v_mfma_f32_16x16x32_bf16 v[88:91], v[120:123], v[104:107], 0
    v_mfma_f32_16x16x32_bf16 v[92:95], v[120:123], v[108:111], 0
    v_perm_b32 v112, v15, v11, s68
    v_perm_b32 v113, v23, v19, s68
    v_perm_b32 v114, v31, v27, s68
    v_perm_b32 v115, v39, v35, s68
    v_perm_b32 v116, v15, v11, s69
    v_perm_b32 v117, v23, v19, s69
    v_perm_b32 v118, v31, v27, s69
    v_perm_b32 v119, v39, v35, s69
    s_nop 1
    v_mfma_f32_16x16x32_bf16 v[96:99], v[120:123], v[112:115], 0
    v_mfma_f32_16x16x32_bf16 v[100:103], v[120:123], v[116:119], 0
    ds_read_b128 v[8:11], v3 offset:16384
    ds_read_b128 v[12:15], v3 offset:17408
    ds_read_b128 v[16:19], v3 offset:18432
    ds_read_b128 v[20:23], v3 offset:19456
    ds_read_b128 v[24:27], v3 offset:20480
    ds_read_b128 v[28:31], v3 offset:21504
    ds_read_b128 v[32:35], v3 offset:22528
    ds_read_b128 v[36:39], v3 offset:23552
    s_waitcnt lgkmcnt(8)
    v_perm_b32 v104, v44, v40, s68
    v_perm_b32 v105, v52, v48, s68
    v_perm_b32 v106, v60, v56, s68
    v_perm_b32 v107, v68, v64, s68
    v_perm_b32 v108, v44, v40, s69
    v_perm_b32 v109, v52, v48, s69
    v_perm_b32 v110, v60, v56, s69
    v_perm_b32 v111, v68, v64, s69
    s_nop 1
    v_mfma_f32_16x16x32_bf16 v[72:75], v[124:127], v[104:107], v[72:75]
    v_mfma_f32_16x16x32_bf16 v[76:79], v[124:127], v[108:111], v[76:79]
    v_perm_b32 v112, v45, v41, s68
    v_perm_b32 v113, v53, v49, s68
    v_perm_b32 v114, v61, v57, s68
    v_perm_b32 v115, v69, v65, s68
    v_perm_b32 v116, v45, v41, s69
    v_perm_b32 v117, v53, v49, s69
    v_perm_b32 v118, v61, v57, s69
    v_perm_b32 v119, v69, v65, s69
    s_nop 1
    v_mfma_f32_16x16x32_bf16 v[80:83], v[124:127], v[112:115], v[80:83]
    v_mfma_f32_16x16x32_bf16 v[84:87], v[124:127], v[116:119], v[84:87]
    v_perm_b32 v104, v46, v42, s68
    v_perm_b32 v105, v54, v50, s68
    v_perm_b32 v106, v62, v58, s68
    v_perm_b32 v107, v70, v66, s68
    v_perm_b32 v108, v46, v42, s69
    v_perm_b32 v109, v54, v50, s69
    v_perm_b32 v110, v62, v58, s69
    v_perm_b32 v111, v70, v66, s69
    s_nop 1
    v_mfma_f32_16x16x32_bf16 v[88:91], v[124:127], v[104:107], v[88:91]
    v_mfma_f32_16x16x32_bf16 v[92:95], v[124:127], v[108:111], v[92:95]
    v_perm_b32 v112, v47, v43, s68
    v_perm_b32 v113, v55, v51, s68
    v_perm_b32 v114, v63, v59, s68
    v_perm_b32 v115, v71, v67, s68
    v_perm_b32 v116, v47, v43, s69
    v_perm_b32 v117, v55, v51, s69
    v_perm_b32 v118, v63, v59, s69
    v_perm_b32 v119, v71, v67, s69
    s_nop 1
    v_mfma_f32_16x16x32_bf16 v[96:99], v[124:127], v[112:115], v[96:99]
    v_mfma_f32_16x16x32_bf16 v[100:103], v[124:127], v[116:119], v[100:103]
    ds_read_b128 v[40:43], v3 offset:24576
    ds_read_b128 v[44:47], v3 offset:25600
    ds_read_b128 v[48:51], v3 offset:26624
    ds_read_b128 v[52:55], v3 offset:27648
    ds_read_b128 v[56:59], v3 offset:28672
    ds_read_b128 v[60:63], v3 offset:29696
    ds_read_b128 v[64:67], v3 offset:30720
    ds_read_b128 v[68:71], v3 offset:31744
    s_waitcnt lgkmcnt(8)
    v_perm_b32 v104, v12, v8, s68
    v_perm_b32 v105, v20, v16, s68
    v_perm_b32 v106, v28, v24, s68
    v_perm_b32 v107, v36, v32, s68
    v_perm_b32 v108, v12, v8, s69
    v_perm_b32 v109, v20, v16, s69
    v_perm_b32 v110, v28, v24, s69
    v_perm_b32 v111, v36, v32, s69
    s_nop 1
    v_mfma_f32_16x16x32_bf16 v[72:75], v[128:131], v[104:107], v[72:75]
    v_mfma_f32_16x16x32_bf16 v[76:79], v[128:131], v[108:111], v[76:79]
    v_perm_b32 v112, v13, v9, s68
    v_perm_b32 v113, v21, v17, s68
    v_perm_b32 v114, v29, v25, s68
    v_perm_b32 v115, v37, v33, s68
    v_perm_b32 v116, v13, v9, s69
    v_perm_b32 v117, v21, v17, s69
    v_perm_b32 v118, v29, v25, s69
    v_perm_b32 v119, v37, v33, s69
    s_nop 1
    v_mfma_f32_16x16x32_bf16 v[80:83], v[128:131], v[112:115], v[80:83]
    v_mfma_f32_16x16x32_bf16 v[84:87], v[128:131], v[116:119], v[84:87]
    v_perm_b32 v104, v14, v10, s68
    v_perm_b32 v105, v22, v18, s68
    v_perm_b32 v106, v30, v26, s68
    v_perm_b32 v107, v38, v34, s68
    v_perm_b32 v108, v14, v10, s69
    v_perm_b32 v109, v22, v18, s69
    v_perm_b32 v110, v30, v26, s69
    v_perm_b32 v111, v38, v34, s69
    s_nop 1
    v_mfma_f32_16x16x32_bf16 v[88:91], v[128:131], v[104:107], v[88:91]
    v_mfma_f32_16x16x32_bf16 v[92:95], v[128:131], v[108:111], v[92:95]
    v_perm_b32 v112, v15, v11, s68
    v_perm_b32 v113, v23, v19, s68
    v_perm_b32 v114, v31, v27, s68
    v_perm_b32 v115, v39, v35, s68
    v_perm_b32 v116, v15, v11, s69
    v_perm_b32 v117, v23, v19, s69
    v_perm_b32 v118, v31, v27, s69
    v_perm_b32 v119, v39, v35, s69
    s_nop 1
    v_mfma_f32_16x16x32_bf16 v[96:99], v[128:131], v[112:115], v[96:99]
    v_mfma_f32_16x16x32_bf16 v[100:103], v[128:131], v[116:119], v[100:103]
    s_waitcnt lgkmcnt(0)
    v_perm_b32 v104, v44, v40, s68
    v_perm_b32 v105, v52, v48, s68
    v_perm_b32 v106, v60, v56, s68
    v_perm_b32 v107, v68, v64, s68
    v_perm_b32 v108, v44, v40, s69
    v_perm_b32 v109, v52, v48, s69
    v_perm_b32 v110, v60, v56, s69
    v_perm_b32 v111, v68, v64, s69
    s_nop 1
    v_mfma_f32_16x16x32_bf16 v[72:75], v[132:135], v[104:107], v[72:75]
    v_mfma_f32_16x16x32_bf16 v[76:79], v[132:135], v[108:111], v[76:79]
    v_perm_b32 v112, v45, v41, s68
    v_perm_b32 v113, v53, v49, s68
    v_perm_b32 v114, v61, v57, s68
    v_perm_b32 v115, v69, v65, s68
    v_perm_b32 v116, v45, v41, s69
    v_perm_b32 v117, v53, v49, s69
    v_perm_b32 v118, v61, v57, s69
    v_perm_b32 v119, v69, v65, s69
    s_nop 1
    v_mfma_f32_16x16x32_bf16 v[80:83], v[132:135], v[112:115], v[80:83]
    v_mfma_f32_16x16x32_bf16 v[84:87], v[132:135], v[116:119], v[84:87]
    v_perm_b32 v104, v46, v42, s68
    v_perm_b32 v105, v54, v50, s68
    v_perm_b32 v106, v62, v58, s68
    v_perm_b32 v107, v70, v66, s68
    v_perm_b32 v108, v46, v42, s69
    v_perm_b32 v109, v54, v50, s69
    v_perm_b32 v110, v62, v58, s69
    v_perm_b32 v111, v70, v66, s69
    s_nop 1
    v_mfma_f32_16x16x32_bf16 v[88:91], v[132:135], v[104:107], v[88:91]
    v_mfma_f32_16x16x32_bf16 v[92:95], v[132:135], v[108:111], v[92:95]
    v_perm_b32 v112, v47, v43, s68
    v_perm_b32 v113, v55, v51, s68
    v_perm_b32 v114, v63, v59, s68
    v_perm_b32 v115, v71, v67, s68
    v_perm_b32 v116, v47, v43, s69
    v_perm_b32 v117, v55, v51, s69
    v_perm_b32 v118, v63, v59, s69
    v_perm_b32 v119, v71, v67, s69
    s_nop 1
    v_mfma_f32_16x16x32_bf16 v[96:99], v[132:135], v[112:115], v[96:99]
    v_mfma_f32_16x16x32_bf16 v[100:103], v[132:135], v[116:119], v[100:103]
    s_lshl_b32 s14, s9, 17
    s_add_u32 s15, s8, 32
    s_lshl_b32 s12, s15, 11
    s_add_u32 s14, s14, s12
    s_add_u32 s14, s14, 8388608
    s_lshl_b32 s12, s9, 6
    s_add_u32 s15, s15, s12
    s_lshl_b32 s15, s15, 2
    s_add_u32 s15, s15, 12288
    s_mul_i32 s4, s40, 0x9e3779b1
    s_lshr_b32 s4, s4, 16
    v_mov_b32 v136, s40
    v_lshrrev_b32 v137, 12, v136
    s_lshr_b32 s5, s40, 24
    s_lshl_b32 s6, s4, 8
    s_or_b32 s5, s5, s6
    v_mov_b32 v138, s5
    s_lshr_b32 s4, s4, 4
    v_mov_b32 v139, s4
    s_nop 7
    v_bfi_b32 v8, s89, v136, v72
    v_bfi_b32 v9, s89, v137, v76
    v_bfi_b32 v10, s89, v138, v80
    v_bfi_b32 v11, s89, v139, v84
    v_bfi_b32 v12, s89, v136, v88
    v_bfi_b32 v13, s89, v137, v92
    v_bfi_b32 v14, s89, v138, v96
    v_bfi_b32 v15, s89, v139, v100
    v_bfi_b32 v16, s89, v136, v73
    v_bfi_b32 v17, s89, v137, v77
    v_bfi_b32 v18, s89, v138, v81
    v_bfi_b32 v19, s89, v139, v85
    v_bfi_b32 v20, s89, v136, v89
    v_bfi_b32 v21, s89, v137, v93
    v_bfi_b32 v22, s89, v138, v97
    v_bfi_b32 v23, s89, v139, v101
    v_bfi_b32 v24, s89, v136, v74
    v_bfi_b32 v25, s89, v137, v78
    v_bfi_b32 v26, s89, v138, v82
    v_bfi_b32 v27, s89, v139, v86
    v_bfi_b32 v28, s89, v136, v90
    v_bfi_b32 v29, s89, v137, v94
    v_bfi_b32 v30, s89, v138, v98
    v_bfi_b32 v31, s89, v139, v102
    v_bfi_b32 v32, s89, v136, v75
    v_bfi_b32 v33, s89, v137, v79
    v_bfi_b32 v34, s89, v138, v83
    v_bfi_b32 v35, s89, v139, v87
    v_bfi_b32 v36, s89, v136, v91
    v_bfi_b32 v37, s89, v137, v95
    v_bfi_b32 v38, s89, v138, v99
    v_bfi_b32 v39, s89, v139, v103
    v_lshlrev_b32 v2, 4, v0
    s_mov_b64 exec, 0xffff
    s_add_u32 s5, s14, 0
    buffer_store_dwordx4 v[8:11], v2, s[56:59], s5 offen sc1
    buffer_store_dwordx4 v[12:15], v2, s[56:59], s5 offen offset:256 sc1
    s_add_u32 s5, s14, 512
    buffer_store_dwordx4 v[16:19], v2, s[56:59], s5 offen sc1
    buffer_store_dwordx4 v[20:23], v2, s[56:59], s5 offen offset:256 sc1
    s_add_u32 s5, s14, 1024
    buffer_store_dwordx4 v[24:27], v2, s[56:59], s5 offen sc1
    buffer_store_dwordx4 v[28:31], v2, s[56:59], s5 offen offset:256 sc1
    s_add_u32 s5, s14, 1536
    buffer_store_dwordx4 v[32:35], v2, s[56:59], s5 offen sc1
    buffer_store_dwordx4 v[36:39], v2, s[56:59], s5 offen offset:256 sc1
    s_mov_b64 exec, 1
    v_mov_b32 v2, 0
    s_mov_b64 exec, -1
    s_endpgm
L_w8:
    s_mov_b32 s52, s22
    s_mov_b32 s53, s23
    s_mov_b32 s54, 8388608
    s_mov_b32 s55, 0x00020000
    s_lshr_b32 s8, s2, 3
    s_and_b32 s9, s2, 7
    s_lshl_b32 s10, s9, 8
    v_lshrrev_b32 v2, 4, v0
    v_lshlrev_b32 v2, 11, v2
    v_and_b32 v3, 15, v0
    v_lshlrev_b32 v3, 7, v3
    v_add_u32 v2, v2, v3
    buffer_load_dwordx4 v[8:11], v2, s[60:63], 0 offen offset:0
    buffer_load_dwordx4 v[12:15], v2, s[60:63], 0 offen offset:16
    buffer_load_dwordx4 v[16:19], v2, s[60:63], 0 offen offset:32
    buffer_load_dwordx4 v[20:23], v2, s[60:63], 0 offen offset:48
    buffer_load_dwordx4 v[24:27], v2, s[60:63], 0 offen offset:64
    buffer_load_dwordx4 v[28:31], v2, s[60:63], 0 offen offset:80
    buffer_load_dwordx4 v[32:35], v2, s[60:63], 0 offen offset:96
    buffer_load_dwordx4 v[36:39], v2, s[60:63], 0 offen offset:112
    v_and_b32 v3, 3, v0
    v_lshlrev_b32 v3, 11, v3
    v_lshrrev_b32 v4, 4, v0
    v_lshlrev_b32 v4, 4, v4
    v_add_u32 v3, v3, v4
    buffer_load_dwordx4 v[120:123], v3, s[60:63], s10 offen offset:0
    buffer_load_dwordx4 v[124:127], v3, s[60:63], s10 offen offset:64
    buffer_load_dwordx4 v[128:131], v3, s[60:63], s10 offen offset:128
    buffer_load_dwordx4 v[132:135], v3, s[60:63], s10 offen offset:192
    v_lshrrev_b32 v2, 4, v0
    s_mov_b32 s5, 65536
    v_mul_lo_u32 v2, v2, s5
    v_and_b32 v1, 15, v0
    v_lshlrev_b32 v1, 4, v1
    v_add_u32 v1, v1, v2
    s_mul_i32 s11, s9, 1048576
    s_lshl_b32 s12, s8, 8
    s_add_u32 s11, s11, s12
    s_add_u32 s5, s11, 0
    s_mov_b32 m0, 40960
    s_nop 0
    buffer_load_dwordx4 v1, s[52:55], s5 offen nt lds
    s_add_u32 s5, s11, 8192
    s_mov_b32 m0, 41984
    s_nop 0
    buffer_load_dwordx4 v1, s[52:55], s5 offen nt lds
    s_add_u32 s5, s11, 16384
    s_mov_b32 m0, 43008
    s_nop 0
    buffer_load_dwordx4 v1, s[52:55], s5 offen nt lds
    s_add_u32 s5, s11, 24576
    s_mov_b32 m0, 44032
    s_nop 0
    buffer_load_dwordx4 v1, s[52:55], s5 offen nt lds
    s_add_u32 s5, s11, 32768
    s_mov_b32 m0, 45056
    s_nop 0
    buffer_load_dwordx4 v1, s[52:55], s5 offen nt lds
    s_add_u32 s5, s11, 40960
    s_mov_b32 m0, 46080
    s_nop 0
    buffer_load_dwordx4 v1, s[52:55], s5 offen nt lds
    s_add_u32 s5, s11, 49152
    s_mov_b32 m0, 47104
    s_nop 0
    buffer_load_dwordx4 v1, s[52:55], s5 offen nt lds
    s_add_u32 s5, s11, 57344
    s_mov_b32 m0, 48128
    s_nop 0
    buffer_load_dwordx4 v1, s[52:55], s5 offen nt lds
    s_add_u32 s5, s11, 262144
    s_mov_b32 m0, 49152
    s_nop 0
    buffer_load_dwordx4 v1, s[52:55], s5 offen nt lds
    s_add_u32 s5, s11, 270336
    s_mov_b32 m0, 50176
    s_nop 0
    buffer_load_dwordx4 v1, s[52:55], s5 offen nt lds
    s_add_u32 s5, s11, 278528
    s_mov_b32 m0, 51200
    s_nop 0
    buffer_load_dwordx4 v1, s[52:55], s5 offen nt lds
    s_add_u32 s5, s11, 286720
    s_mov_b32 m0, 52224
    s_nop 0
    buffer_load_dwordx4 v1, s[52:55], s5 offen nt lds
    s_add_u32 s5, s11, 294912
    s_mov_b32 m0, 53248
    s_nop 0
    buffer_load_dwordx4 v1, s[52:55], s5 offen nt lds
    s_add_u32 s5, s11, 303104
    s_mov_b32 m0, 54272
    s_nop 0
    buffer_load_dwordx4 v1, s[52:55], s5 offen nt lds
    s_add_u32 s5, s11, 311296
    s_mov_b32 m0, 55296
    s_nop 0
    buffer_load_dwordx4 v1, s[52:55], s5 offen nt lds
    s_add_u32 s5, s11, 319488
    s_mov_b32 m0, 56320
    s_nop 0
    buffer_load_dwordx4 v1, s[52:55], s5 offen nt lds
    s_add_u32 s5, s11, 524288
    s_mov_b32 m0, 57344
    s_nop 0
    buffer_load_dwordx4 v1, s[52:55], s5 offen nt lds
    s_add_u32 s5, s11, 532480
    s_mov_b32 m0, 58368
    s_nop 0
    buffer_load_dwordx4 v1, s[52:55], s5 offen nt lds
    s_add_u32 s5, s11, 540672
    s_mov_b32 m0, 59392
    s_nop 0
    buffer_load_dwordx4 v1, s[52:55], s5 offen nt lds
    s_add_u32 s5, s11, 548864
    s_mov_b32 m0, 60416
    s_nop 0
    buffer_load_dwordx4 v1, s[52:55], s5 offen nt lds
    s_add_u32 s5, s11, 557056
    s_mov_b32 m0, 61440
    s_nop 0
    buffer_load_dwordx4 v1, s[52:55], s5 offen nt lds
    s_add_u32 s5, s11, 565248
    s_mov_b32 m0, 62464
    s_nop 0
    buffer_load_dwordx4 v1, s[52:55], s5 offen nt lds
    s_add_u32 s5, s11, 573440
    s_mov_b32 m0, 63488
    s_nop 0
    buffer_load_dwordx4 v1, s[52:55], s5 offen nt lds
    s_add_u32 s5, s11, 581632
    s_mov_b32 m0, 64512
    s_nop 0
    buffer_load_dwordx4 v1, s[52:55], s5 offen nt lds
    s_add_u32 s5, s11, 786432
    s_mov_b32 m0, 65536
    s_nop 0
    buffer_load_dwordx4 v1, s[52:55], s5 offen nt lds
    s_add_u32 s5, s11, 794624
    s_mov_b32 m0, 66560
    s_nop 0
    buffer_load_dwordx4 v1, s[52:55], s5 offen nt lds
    s_add_u32 s5, s11, 802816
    s_mov_b32 m0, 67584
    s_nop 0
    buffer_load_dwordx4 v1, s[52:55], s5 offen nt lds
    s_add_u32 s5, s11, 811008
    s_mov_b32 m0, 68608
    s_nop 0
    buffer_load_dwordx4 v1, s[52:55], s5 offen nt lds
    s_add_u32 s5, s11, 819200
    s_mov_b32 m0, 69632
    s_nop 0
    buffer_load_dwordx4 v1, s[52:55], s5 offen nt lds
    s_add_u32 s5, s11, 827392
    s_mov_b32 m0, 70656
    s_nop 0
    buffer_load_dwordx4 v1, s[52:55], s5 offen nt lds
    s_add_u32 s5, s11, 835584
    s_mov_b32 m0, 71680
    s_nop 0
    buffer_load_dwordx4 v1, s[52:55], s5 offen nt lds
    s_add_u32 s5, s11, 843776
    s_mov_b32 m0, 72704
    s_nop 0
    buffer_load_dwordx4 v1, s[52:55], s5 offen nt lds
    s_waitcnt lgkmcnt(0)
    s_barrier
    s_add_u32 s40, s40, 1
    s_waitcnt vmcnt(32)
    v_mov_b32 v2, 0
    v_mov_b32 v3, 0
    v_lshlrev_b32 v4, 16, v8
    v_and_b32 v5, 0xffff0000, v8
    v_add_f32 v2, v2, v4
    v_add_f32 v3, v3, v5
    v_lshlrev_b32 v4, 16, v9
    v_and_b32 v5, 0xffff0000, v9
    v_add_f32 v2, v2, v4
    v_add_f32 v3, v3, v5
    v_lshlrev_b32 v4, 16, v10
    v_and_b32 v5, 0xffff0000, v10
    v_add_f32 v2, v2, v4
    v_add_f32 v3, v3, v5
    v_lshlrev_b32 v4, 16, v11
    v_and_b32 v5, 0xffff0000, v11
    v_add_f32 v2, v2, v4
    v_add_f32 v3, v3, v5
    v_lshlrev_b32 v4, 16, v12
    v_and_b32 v5, 0xffff0000, v12
    v_add_f32 v2, v2, v4
    v_add_f32 v3, v3, v5
    v_lshlrev_b32 v4, 16, v13
    v_and_b32 v5, 0xffff0000, v13
    v_add_f32 v2, v2, v4
    v_add_f32 v3, v3, v5
    v_lshlrev_b32 v4, 16, v14
    v_and_b32 v5, 0xffff0000, v14
    v_add_f32 v2, v2, v4
    v_add_f32 v3, v3, v5
    v_lshlrev_b32 v4, 16, v15
    v_and_b32 v5, 0xffff0000, v15
    v_add_f32 v2, v2, v4
    v_add_f32 v3, v3, v5
    v_lshlrev_b32 v4, 16, v16
    v_and_b32 v5, 0xffff0000, v16
    v_add_f32 v2, v2, v4
    v_add_f32 v3, v3, v5
    v_lshlrev_b32 v4, 16, v17
    v_and_b32 v5, 0xffff0000, v17
    v_add_f32 v2, v2, v4
    v_add_f32 v3, v3, v5
    v_lshlrev_b32 v4, 16, v18
    v_and_b32 v5, 0xffff0000, v18
    v_add_f32 v2, v2, v4
    v_add_f32 v3, v3, v5
    v_lshlrev_b32 v4, 16, v19
    v_and_b32 v5, 0xffff0000, v19
    v_add_f32 v2, v2, v4
    v_add_f32 v3, v3, v5
    v_lshlrev_b32 v4, 16, v20
    v_and_b32 v5, 0xffff0000, v20
    v_add_f32 v2, v2, v4
    v_add_f32 v3, v3, v5
    v_lshlrev_b32 v4, 16, v21
    v_and_b32 v5, 0xffff0000, v21
    v_add_f32 v2, v2, v4
    v_add_f32 v3, v3, v5
    v_lshlrev_b32 v4, 16, v22
    v_and_b32 v5, 0xffff0000, v22
    v_add_f32 v2, v2, v4
    v_add_f32 v3, v3, v5
    v_lshlrev_b32 v4, 16, v23
    v_and_b32 v5, 0xffff0000, v23
    v_add_f32 v2, v2, v4
    v_add_f32 v3, v3, v5
    v_lshlrev_b32 v4, 16, v24
    v_and_b32 v5, 0xffff0000, v24
    v_add_f32 v2, v2, v4
    v_add_f32 v3, v3, v5
    v_lshlrev_b32 v4, 16, v25
    v_and_b32 v5, 0xffff0000, v25
    v_add_f32 v2, v2, v4
    v_add_f32 v3, v3, v5
    v_lshlrev_b32 v4, 16, v26
    v_and_b32 v5, 0xffff0000, v26
    v_add_f32 v2, v2, v4
    v_add_f32 v3, v3, v5
    v_lshlrev_b32 v4, 16, v27
    v_and_b32 v5, 0xffff0000, v27
    v_add_f32 v2, v2, v4
    v_add_f32 v3, v3, v5
    v_lshlrev_b32 v4, 16, v28
    v_and_b32 v5, 0xffff0000, v28
    v_add_f32 v2, v2, v4
    v_add_f32 v3, v3, v5
    v_lshlrev_b32 v4, 16, v29
    v_and_b32 v5, 0xffff0000, v29
    v_add_f32 v2, v2, v4
    v_add_f32 v3, v3, v5
    v_lshlrev_b32 v4, 16, v30
    v_and_b32 v5, 0xffff0000, v30
    v_add_f32 v2, v2, v4
    v_add_f32 v3, v3, v5
    v_lshlrev_b32 v4, 16, v31
    v_and_b32 v5, 0xffff0000, v31
    v_add_f32 v2, v2, v4
    v_add_f32 v3, v3, v5
    v_lshlrev_b32 v4, 16, v32
    v_and_b32 v5, 0xffff0000, v32
    v_add_f32 v2, v2, v4
    v_add_f32 v3, v3, v5
    v_lshlrev_b32 v4, 16, v33
    v_and_b32 v5, 0xffff0000, v33
    v_add_f32 v2, v2, v4
    v_add_f32 v3, v3, v5
    v_lshlrev_b32 v4, 16, v34
    v_and_b32 v5, 0xffff0000, v34
    v_add_f32 v2, v2, v4
    v_add_f32 v3, v3, v5
    v_lshlrev_b32 v4, 16, v35
    v_and_b32 v5, 0xffff0000, v35
    v_add_f32 v2, v2, v4
    v_add_f32 v3, v3, v5
    v_lshlrev_b32 v4, 16, v36
    v_and_b32 v5, 0xffff0000, v36
    v_add_f32 v2, v2, v4
    v_add_f32 v3, v3, v5
    v_lshlrev_b32 v4, 16, v37
    v_and_b32 v5, 0xffff0000, v37
    v_add_f32 v2, v2, v4
    v_add_f32 v3, v3, v5
    v_lshlrev_b32 v4, 16, v38
    v_and_b32 v5, 0xffff0000, v38
    v_add_f32 v2, v2, v4
    v_add_f32 v3, v3, v5
    v_lshlrev_b32 v4, 16, v39
    v_and_b32 v5, 0xffff0000, v39
    v_add_f32 v2, v2, v4
    v_add_f32 v3, v3, v5
    v_add_f32 v2, v2, v3
    s_nop 1
    v_add_f32_dpp v2, v2, v2 row_ror:8 row_mask:0xf bank_mask:0xf
    s_nop 1
    v_add_f32_dpp v2, v2, v2 row_ror:4 row_mask:0xf bank_mask:0xf
    s_nop 1
    v_add_f32_dpp v2, v2, v2 row_ror:2 row_mask:0xf bank_mask:0xf
    s_nop 1
    v_add_f32_dpp v2, v2, v2 row_ror:1 row_mask:0xf bank_mask:0xf
    v_mul_f32 v2, 0x3a800000, v2
    v_mov_b32 v3, 0
    v_mov_b32 v6, 0
    v_lshlrev_b32 v4, 16, v8
    v_and_b32 v5, 0xffff0000, v8
    v_sub_f32 v4, v4, v2
    v_sub_f32 v5, v5, v2
    v_fmac_f32 v3, v4, v4
    v_fmac_f32 v6, v5, v5
    v_lshlrev_b32 v4, 16, v9
    v_and_b32 v5, 0xffff0000, v9
    v_sub_f32 v4, v4, v2
    v_sub_f32 v5, v5, v2
    v_fmac_f32 v3, v4, v4
    v_fmac_f32 v6, v5, v5
    v_lshlrev_b32 v4, 16, v10
    v_and_b32 v5, 0xffff0000, v10
    v_sub_f32 v4, v4, v2
    v_sub_f32 v5, v5, v2
    v_fmac_f32 v3, v4, v4
    v_fmac_f32 v6, v5, v5
    v_lshlrev_b32 v4, 16, v11
    v_and_b32 v5, 0xffff0000, v11
    v_sub_f32 v4, v4, v2
    v_sub_f32 v5, v5, v2
    v_fmac_f32 v3, v4, v4
    v_fmac_f32 v6, v5, v5
    v_lshlrev_b32 v4, 16, v12
    v_and_b32 v5, 0xffff0000, v12
    v_sub_f32 v4, v4, v2
    v_sub_f32 v5, v5, v2
    v_fmac_f32 v3, v4, v4
    v_fmac_f32 v6, v5, v5
    v_lshlrev_b32 v4, 16, v13
    v_and_b32 v5, 0xffff0000, v13
    v_sub_f32 v4, v4, v2
    v_sub_f32 v5, v5, v2
    v_fmac_f32 v3, v4, v4
    v_fmac_f32 v6, v5, v5
    v_lshlrev_b32 v4, 16, v14
    v_and_b32 v5, 0xffff0000, v14
    v_sub_f32 v4, v4, v2
    v_sub_f32 v5, v5, v2
    v_fmac_f32 v3, v4, v4
    v_fmac_f32 v6, v5, v5
    v_lshlrev_b32 v4, 16, v15
    v_and_b32 v5, 0xffff0000, v15
    v_sub_f32 v4, v4, v2
    v_sub_f32 v5, v5, v2
    v_fmac_f32 v3, v4, v4
    v_fmac_f32 v6, v5, v5
    v_lshlrev_b32 v4, 16, v16
    v_and_b32 v5, 0xffff0000, v16
    v_sub_f32 v4, v4, v2
    v_sub_f32 v5, v5, v2
    v_fmac_f32 v3, v4, v4
    v_fmac_f32 v6, v5, v5
    v_lshlrev_b32 v4, 16, v17
    v_and_b32 v5, 0xffff0000, v17
    v_sub_f32 v4, v4, v2
    v_sub_f32 v5, v5, v2
    v_fmac_f32 v3, v4, v4
    v_fmac_f32 v6, v5, v5
    v_lshlrev_b32 v4, 16, v18
    v_and_b32 v5, 0xffff0000, v18
    v_sub_f32 v4, v4, v2
    v_sub_f32 v5, v5, v2
    v_fmac_f32 v3, v4, v4
    v_fmac_f32 v6, v5, v5
    v_lshlrev_b32 v4, 16, v19
    v_and_b32 v5, 0xffff0000, v19
    v_sub_f32 v4, v4, v2
    v_sub_f32 v5, v5, v2
    v_fmac_f32 v3, v4, v4
    v_fmac_f32 v6, v5, v5
    v_lshlrev_b32 v4, 16, v20
    v_and_b32 v5, 0xffff0000, v20
    v_sub_f32 v4, v4, v2
    v_sub_f32 v5, v5, v2
    v_fmac_f32 v3, v4, v4
    v_fmac_f32 v6, v5, v5
    v_lshlrev_b32 v4, 16, v21
    v_and_b32 v5, 0xffff0000, v21
    v_sub_f32 v4, v4, v2
    v_sub_f32 v5, v5, v2
    v_fmac_f32 v3, v4, v4
    v_fmac_f32 v6, v5, v5
    v_lshlrev_b32 v4, 16, v22
    v_and_b32 v5, 0xffff0000, v22
    v_sub_f32 v4, v4, v2
    v_sub_f32 v5, v5, v2
    v_fmac_f32 v3, v4, v4
    v_fmac_f32 v6, v5, v5
    v_lshlrev_b32 v4, 16, v23
    v_and_b32 v5, 0xffff0000, v23
    v_sub_f32 v4, v4, v2
    v_sub_f32 v5, v5, v2
    v_fmac_f32 v3, v4, v4
    v_fmac_f32 v6, v5, v5
    v_lshlrev_b32 v4, 16, v24
    v_and_b32 v5, 0xffff0000, v24
    v_sub_f32 v4, v4, v2
    v_sub_f32 v5, v5, v2
    v_fmac_f32 v3, v4, v4
    v_fmac_f32 v6, v5, v5
    v_lshlrev_b32 v4, 16, v25
    v_and_b32 v5, 0xffff0000, v25
    v_sub_f32 v4, v4, v2
    v_sub_f32 v5, v5, v2
    v_fmac_f32 v3, v4, v4
    v_fmac_f32 v6, v5, v5
    v_lshlrev_b32 v4, 16, v26
    v_and_b32 v5, 0xffff0000, v26
    v_sub_f32 v4, v4, v2
    v_sub_f32 v5, v5, v2
    v_fmac_f32 v3, v4, v4
    v_fmac_f32 v6, v5, v5
    v_lshlrev_b32 v4, 16, v27
    v_and_b32 v5, 0xffff0000, v27
    v_sub_f32 v4, v4, v2
    v_sub_f32 v5, v5, v2
    v_fmac_f32 v3, v4, v4
    v_fmac_f32 v6, v5, v5
    v_lshlrev_b32 v4, 16, v28
    v_and_b32 v5, 0xffff0000, v28
    v_sub_f32 v4, v4, v2
    v_sub_f32 v5, v5, v2
    v_fmac_f32 v3, v4, v4
    v_fmac_f32 v6, v5, v5
    v_lshlrev_b32 v4, 16, v29
    v_and_b32 v5, 0xffff0000, v29
    v_sub_f32 v4, v4, v2
    v_sub_f32 v5, v5, v2
    v_fmac_f32 v3, v4, v4
    v_fmac_f32 v6, v5, v5
    v_lshlrev_b32 v4, 16, v30
    v_and_b32 v5, 0xffff0000, v30
    v_sub_f32 v4, v4, v2
    v_sub_f32 v5, v5, v2
    v_fmac_f32 v3, v4, v4
    v_fmac_f32 v6, v5, v5
    v_lshlrev_b32 v4, 16, v31
    v_and_b32 v5, 0xffff0000, v31
    v_sub_f32 v4, v4, v2
    v_sub_f32 v5, v5, v2
    v_fmac_f32 v3, v4, v4
    v_fmac_f32 v6, v5, v5
    v_lshlrev_b32 v4, 16, v32
    v_and_b32 v5, 0xffff0000, v32
    v_sub_f32 v4, v4, v2
    v_sub_f32 v5, v5, v2
    v_fmac_f32 v3, v4, v4
    v_fmac_f32 v6, v5, v5
    v_lshlrev_b32 v4, 16, v33
    v_and_b32 v5, 0xffff0000, v33
    v_sub_f32 v4, v4, v2
    v_sub_f32 v5, v5, v2
    v_fmac_f32 v3, v4, v4
    v_fmac_f32 v6, v5, v5
    v_lshlrev_b32 v4, 16, v34
    v_and_b32 v5, 0xffff0000, v34
    v_sub_f32 v4, v4, v2
    v_sub_f32 v5, v5, v2
    v_fmac_f32 v3, v4, v4
    v_fmac_f32 v6, v5, v5
    v_lshlrev_b32 v4, 16, v35
    v_and_b32 v5, 0xffff0000, v35
    v_sub_f32 v4, v4, v2
    v_sub_f32 v5, v5, v2
    v_fmac_f32 v3, v4, v4
    v_fmac_f32 v6, v5, v5
    v_lshlrev_b32 v4, 16, v36
    v_and_b32 v5, 0xffff0000, v36
    v_sub_f32 v4, v4, v2
    v_sub_f32 v5, v5, v2
    v_fmac_f32 v3, v4, v4
    v_fmac_f32 v6, v5, v5
    v_lshlrev_b32 v4, 16, v37
    v_and_b32 v5, 0xffff0000, v37
    v_sub_f32 v4, v4, v2
    v_sub_f32 v5, v5, v2
    v_fmac_f32 v3, v4, v4
    v_fmac_f32 v6, v5, v5
    v_lshlrev_b32 v4, 16, v38
    v_and_b32 v5, 0xffff0000, v38
    v_sub_f32 v4, v4, v2
    v_sub_f32 v5, v5, v2
    v_fmac_f32 v3, v4, v4
    v_fmac_f32 v6, v5, v5
    v_lshlrev_b32 v4, 16, v39
    v_and_b32 v5, 0xffff0000, v39
    v_sub_f32 v4, v4, v2
    v_sub_f32 v5, v5, v2
    v_fmac_f32 v3, v4, v4
    v_fmac_f32 v6, v5, v5
    v_add_f32 v3, v3, v6
    s_nop 1
    v_add_f32_dpp v3, v3, v3 row_ror:8 row_mask:0xf bank_mask:0xf
    s_nop 1
    v_add_f32_dpp v3, v3, v3 row_ror:4 row_mask:0xf bank_mask:0xf
    s_nop 1
    v_add_f32_dpp v3, v3, v3 row_ror:2 row_mask:0xf bank_mask:0xf
    s_nop 1
    v_add_f32_dpp v3, v3, v3 row_ror:1 row_mask:0xf bank_mask:0xf
    v_mul_f32 v3, 0x3a800000, v3
    v_cvt_pk_bf16_f32 v2, v2, v2
    v_lshlrev_b32 v2, 16, v2
    v_cvt_pk_bf16_f32 v3, v3, v3
    v_lshlrev_b32 v3, 16, v3
    v_add_f32 v3, 0x3727c5ac, v3
    v_cvt_pk_bf16_f32 v3, v3, v3
    v_lshlrev_b32 v3, 16, v3
    v_sqrt_f32 v3, v3
    s_nop 0
    v_cvt_pk_bf16_f32 v3, v3, v3
    v_lshlrev_b32 v3, 16, v3
    v_and_b32 v4, 3, v0
    v_lshlrev_b32 v4, 6, v4
    ds_bpermute_b32 v2, v4, v2
    ds_bpermute_b32 v3, v4, v3
    s_waitcnt lgkmcnt(0)
    v_rcp_f32 v4, v3
    s_nop 0
    v_lshlrev_b32 v5, 16, v120
    v_and_b32 v6, 0xffff0000, v120
    v_sub_f32 v5, v5, v2
    v_sub_f32 v6, v6, v2
    v_cvt_pk_bf16_f32 v7, v5, v6
    v_lshlrev_b32 v5, 16, v7
    v_and_b32 v6, 0xffff0000, v7
    v_mul_f32 v136, v5, v4
    v_mul_f32 v137, v6, v4
    v_fma_f32 v5, -v136, v3, v5
    v_fma_f32 v6, -v137, v3, v6
    v_fma_f32 v136, v5, v4, v136
    v_fma_f32 v137, v6, v4, v137
    v_cvt_pk_bf16_f32 v120, v136, v137
    v_lshlrev_b32 v5, 16, v121
    v_and_b32 v6, 0xffff0000, v121
    v_sub_f32 v5, v5, v2
    v_sub_f32 v6, v6, v2
    v_cvt_pk_bf16_f32 v7, v5, v6
    v_lshlrev_b32 v5, 16, v7
    v_and_b32 v6, 0xffff0000, v7
    v_mul_f32 v136, v5, v4
    v_mul_f32 v137, v6, v4
    v_fma_f32 v5, -v136, v3, v5
    v_fma_f32 v6, -v137, v3, v6
    v_fma_f32 v136, v5, v4, v136
    v_fma_f32 v137, v6, v4, v137
    v_cvt_pk_bf16_f32 v121, v136, v137
    v_lshlrev_b32 v5, 16, v122
    v_and_b32 v6, 0xffff0000, v122
    v_sub_f32 v5, v5, v2
    v_sub_f32 v6, v6, v2
    v_cvt_pk_bf16_f32 v7, v5, v6
    v_lshlrev_b32 v5, 16, v7
    v_and_b32 v6, 0xffff0000, v7
    v_mul_f32 v136, v5, v4
    v_mul_f32 v137, v6, v4
    v_fma_f32 v5, -v136, v3, v5
    v_fma_f32 v6, -v137, v3, v6
    v_fma_f32 v136, v5, v4, v136
    v_fma_f32 v137, v6, v4, v137
    v_cvt_pk_bf16_f32 v122, v136, v137
    v_lshlrev_b32 v5, 16, v123
    v_and_b32 v6, 0xffff0000, v123
    v_sub_f32 v5, v5, v2
    v_sub_f32 v6, v6, v2
    v_cvt_pk_bf16_f32 v7, v5, v6
    v_lshlrev_b32 v5, 16, v7
    v_and_b32 v6, 0xffff0000, v7
    v_mul_f32 v136, v5, v4
    v_mul_f32 v137, v6, v4
    v_fma_f32 v5, -v136, v3, v5
    v_fma_f32 v6, -v137, v3, v6
    v_fma_f32 v136, v5, v4, v136
    v_fma_f32 v137, v6, v4, v137
    v_cvt_pk_bf16_f32 v123, v136, v137
    v_lshlrev_b32 v5, 16, v124
    v_and_b32 v6, 0xffff0000, v124
    v_sub_f32 v5, v5, v2
    v_sub_f32 v6, v6, v2
    v_cvt_pk_bf16_f32 v7, v5, v6
    v_lshlrev_b32 v5, 16, v7
    v_and_b32 v6, 0xffff0000, v7
    v_mul_f32 v136, v5, v4
    v_mul_f32 v137, v6, v4
    v_fma_f32 v5, -v136, v3, v5
    v_fma_f32 v6, -v137, v3, v6
    v_fma_f32 v136, v5, v4, v136
    v_fma_f32 v137, v6, v4, v137
    v_cvt_pk_bf16_f32 v124, v136, v137
    v_lshlrev_b32 v5, 16, v125
    v_and_b32 v6, 0xffff0000, v125
    v_sub_f32 v5, v5, v2
    v_sub_f32 v6, v6, v2
    v_cvt_pk_bf16_f32 v7, v5, v6
    v_lshlrev_b32 v5, 16, v7
    v_and_b32 v6, 0xffff0000, v7
    v_mul_f32 v136, v5, v4
    v_mul_f32 v137, v6, v4
    v_fma_f32 v5, -v136, v3, v5
    v_fma_f32 v6, -v137, v3, v6
    v_fma_f32 v136, v5, v4, v136
    v_fma_f32 v137, v6, v4, v137
    v_cvt_pk_bf16_f32 v125, v136, v137
    v_lshlrev_b32 v5, 16, v126
    v_and_b32 v6, 0xffff0000, v126
    v_sub_f32 v5, v5, v2
    v_sub_f32 v6, v6, v2
    v_cvt_pk_bf16_f32 v7, v5, v6
    v_lshlrev_b32 v5, 16, v7
    v_and_b32 v6, 0xffff0000, v7
    v_mul_f32 v136, v5, v4
    v_mul_f32 v137, v6, v4
    v_fma_f32 v5, -v136, v3, v5
    v_fma_f32 v6, -v137, v3, v6
    v_fma_f32 v136, v5, v4, v136
    v_fma_f32 v137, v6, v4, v137
    v_cvt_pk_bf16_f32 v126, v136, v137
    v_lshlrev_b32 v5, 16, v127
    v_and_b32 v6, 0xffff0000, v127
    v_sub_f32 v5, v5, v2
    v_sub_f32 v6, v6, v2
    v_cvt_pk_bf16_f32 v7, v5, v6
    v_lshlrev_b32 v5, 16, v7
    v_and_b32 v6, 0xffff0000, v7
    v_mul_f32 v136, v5, v4
    v_mul_f32 v137, v6, v4
    v_fma_f32 v5, -v136, v3, v5
    v_fma_f32 v6, -v137, v3, v6
    v_fma_f32 v136, v5, v4, v136
    v_fma_f32 v137, v6, v4, v137
    v_cvt_pk_bf16_f32 v127, v136, v137
    v_lshlrev_b32 v5, 16, v128
    v_and_b32 v6, 0xffff0000, v128
    v_sub_f32 v5, v5, v2
    v_sub_f32 v6, v6, v2
    v_cvt_pk_bf16_f32 v7, v5, v6
    v_lshlrev_b32 v5, 16, v7
    v_and_b32 v6, 0xffff0000, v7
    v_mul_f32 v136, v5, v4
    v_mul_f32 v137, v6, v4
    v_fma_f32 v5, -v136, v3, v5
    v_fma_f32 v6, -v137, v3, v6
    v_fma_f32 v136, v5, v4, v136
    v_fma_f32 v137, v6, v4, v137
    v_cvt_pk_bf16_f32 v128, v136, v137
    v_lshlrev_b32 v5, 16, v129
    v_and_b32 v6, 0xffff0000, v129
    v_sub_f32 v5, v5, v2
    v_sub_f32 v6, v6, v2
    v_cvt_pk_bf16_f32 v7, v5, v6
    v_lshlrev_b32 v5, 16, v7
    v_and_b32 v6, 0xffff0000, v7
    v_mul_f32 v136, v5, v4
    v_mul_f32 v137, v6, v4
    v_fma_f32 v5, -v136, v3, v5
    v_fma_f32 v6, -v137, v3, v6
    v_fma_f32 v136, v5, v4, v136
    v_fma_f32 v137, v6, v4, v137
    v_cvt_pk_bf16_f32 v129, v136, v137
    v_lshlrev_b32 v5, 16, v130
    v_and_b32 v6, 0xffff0000, v130
    v_sub_f32 v5, v5, v2
    v_sub_f32 v6, v6, v2
    v_cvt_pk_bf16_f32 v7, v5, v6
    v_lshlrev_b32 v5, 16, v7
    v_and_b32 v6, 0xffff0000, v7
    v_mul_f32 v136, v5, v4
    v_mul_f32 v137, v6, v4
    v_fma_f32 v5, -v136, v3, v5
    v_fma_f32 v6, -v137, v3, v6
    v_fma_f32 v136, v5, v4, v136
    v_fma_f32 v137, v6, v4, v137
    v_cvt_pk_bf16_f32 v130, v136, v137
    v_lshlrev_b32 v5, 16, v131
    v_and_b32 v6, 0xffff0000, v131
    v_sub_f32 v5, v5, v2
    v_sub_f32 v6, v6, v2
    v_cvt_pk_bf16_f32 v7, v5, v6
    v_lshlrev_b32 v5, 16, v7
    v_and_b32 v6, 0xffff0000, v7
    v_mul_f32 v136, v5, v4
    v_mul_f32 v137, v6, v4
    v_fma_f32 v5, -v136, v3, v5
    v_fma_f32 v6, -v137, v3, v6
    v_fma_f32 v136, v5, v4, v136
    v_fma_f32 v137, v6, v4, v137
    v_cvt_pk_bf16_f32 v131, v136, v137
    v_lshlrev_b32 v5, 16, v132
    v_and_b32 v6, 0xffff0000, v132
    v_sub_f32 v5, v5, v2
    v_sub_f32 v6, v6, v2
    v_cvt_pk_bf16_f32 v7, v5, v6
    v_lshlrev_b32 v5, 16, v7
    v_and_b32 v6, 0xffff0000, v7
    v_mul_f32 v136, v5, v4
    v_mul_f32 v137, v6, v4
    v_fma_f32 v5, -v136, v3, v5
    v_fma_f32 v6, -v137, v3, v6
    v_fma_f32 v136, v5, v4, v136
    v_fma_f32 v137, v6, v4, v137
    v_cvt_pk_bf16_f32 v132, v136, v137
    v_lshlrev_b32 v5, 16, v133
    v_and_b32 v6, 0xffff0000, v133
    v_sub_f32 v5, v5, v2
    v_sub_f32 v6, v6, v2
    v_cvt_pk_bf16_f32 v7, v5, v6
    v_lshlrev_b32 v5, 16, v7
    v_and_b32 v6, 0xffff0000, v7
    v_mul_f32 v136, v5, v4
    v_mul_f32 v137, v6, v4
    v_fma_f32 v5, -v136, v3, v5
    v_fma_f32 v6, -v137, v3, v6
    v_fma_f32 v136, v5, v4, v136
    v_fma_f32 v137, v6, v4, v137
    v_cvt_pk_bf16_f32 v133, v136, v137
    v_lshlrev_b32 v5, 16, v134
    v_and_b32 v6, 0xffff0000, v134
    v_sub_f32 v5, v5, v2
    v_sub_f32 v6, v6, v2
    v_cvt_pk_bf16_f32 v7, v5, v6
    v_lshlrev_b32 v5, 16, v7
    v_and_b32 v6, 0xffff0000, v7
    v_mul_f32 v136, v5, v4
    v_mul_f32 v137, v6, v4
    v_fma_f32 v5, -v136, v3, v5
    v_fma_f32 v6, -v137, v3, v6
    v_fma_f32 v136, v5, v4, v136
    v_fma_f32 v137, v6, v4, v137
    v_cvt_pk_bf16_f32 v134, v136, v137
    v_lshlrev_b32 v5, 16, v135
    v_and_b32 v6, 0xffff0000, v135
    v_sub_f32 v5, v5, v2
    v_sub_f32 v6, v6, v2
    v_cvt_pk_bf16_f32 v7, v5, v6
    v_lshlrev_b32 v5, 16, v7
    v_and_b32 v6, 0xffff0000, v7
    v_mul_f32 v136, v5, v4
    v_mul_f32 v137, v6, v4
    v_fma_f32 v5, -v136, v3, v5
    v_fma_f32 v6, -v137, v3, v6
    v_fma_f32 v136, v5, v4, v136
    v_fma_f32 v137, v6, v4, v137
    v_cvt_pk_bf16_f32 v135, v136, v137
    s_waitcnt vmcnt(0)
    v_lshlrev_b32 v2, 4, v0
    v_add_u32 v3, 40960, v2
    ds_read_b128 v[8:11], v3 offset:0
    ds_read_b128 v[12:15], v3 offset:1024
    ds_read_b128 v[16:19], v3 offset:2048
    ds_read_b128 v[20:23], v3 offset:3072
    ds_read_b128 v[24:27], v3 offset:4096
    ds_read_b128 v[28:31], v3 offset:5120
    ds_read_b128 v[32:35], v3 offset:6144
    ds_read_b128 v[36:39], v3 offset:7168
    ds_read_b128 v[40:43], v3 offset:8192
    ds_read_b128 v[44:47], v3 offset:9216
    ds_read_b128 v[48:51], v3 offset:10240
    ds_read_b128 v[52:55], v3 offset:11264
    ds_read_b128 v[56:59], v3 offset:12288
    ds_read_b128 v[60:63], v3 offset:13312
    ds_read_b128 v[64:67], v3 offset:14336
    ds_read_b128 v[68:71], v3 offset:15360
    s_waitcnt lgkmcnt(8)
    v_perm_b32 v104, v12, v8, s68
    v_perm_b32 v105, v20, v16, s68
    v_perm_b32 v106, v28, v24, s68
    v_perm_b32 v107, v36, v32, s68
    v_perm_b32 v108, v12, v8, s69
    v_perm_b32 v109, v20, v16, s69
    v_perm_b32 v110, v28, v24, s69
    v_perm_b32 v111, v36, v32, s69
    s_nop 1
    v_mfma_f32_16x16x32_bf16 v[72:75], v[120:123], v[104:107], 0
    v_mfma_f32_16x16x32_bf16 v[76:79], v[120:123], v[108:111], 0
    v_perm_b32 v112, v13, v9, s68
    v_perm_b32 v113, v21, v17, s68
    v_perm_b32 v114, v29, v25, s68
    v_perm_b32 v115, v37, v33, s68
    v_perm_b32 v116, v13, v9, s69
    v_perm_b32 v117, v21, v17, s69
    v_perm_b32 v118, v29, v25, s69
    v_perm_b32 v119, v37, v33, s69
    s_nop 1
    v_mfma_f32_16x16x32_bf16 v[80:83], v[120:123], v[112:115], 0
    v_mfma_f32_16x16x32_bf16 v[84:87], v[120:123], v[116:119], 0
    v_perm_b32 v104, v14, v10, s68
    v_perm_b32 v105, v22, v18, s68
    v_perm_b32 v106, v30, v26, s68
    v_perm_b32 v107, v38, v34, s68
    v_perm_b32 v108, v14, v10, s69
    v_perm_b32 v109, v22, v18, s69
    v_perm_b32 v110, v30, v26, s69
    v_perm_b32 v111, v38, v34, s69
    s_nop 1
    v_mfma_f32_16x16x32_bf16 v[88:91], v[120:123], v[104:107], 0
    v_mfma_f32_16x16x32_bf16 v[92:95], v[120:123], v[108:111], 0
    v_perm_b32 v112, v15, v11, s68
    v_perm_b32 v113, v23, v19, s68
    v_perm_b32 v114, v31, v27, s68
    v_perm_b32 v115, v39, v35, s68
    v_perm_b32 v116, v15, v11, s69
    v_perm_b32 v117, v23, v19, s69
    v_perm_b32 v118, v31, v27, s69
    v_perm_b32 v119, v39, v35, s69
    s_nop 1
    v_mfma_f32_16x16x32_bf16 v[96:99], v[120:123], v[112:115], 0
    v_mfma_f32_16x16x32_bf16 v[100:103], v[120:123], v[116:119], 0
    ds_read_b128 v[8:11], v3 offset:16384
    ds_read_b128 v[12:15], v3 offset:17408
    ds_read_b128 v[16:19], v3 offset:18432
    ds_read_b128 v[20:23], v3 offset:19456
    ds_read_b128 v[24:27], v3 offset:20480
    ds_read_b128 v[28:31], v3 offset:21504
    ds_read_b128 v[32:35], v3 offset:22528
    ds_read_b128 v[36:39], v3 offset:23552
    s_waitcnt lgkmcnt(8)
    v_perm_b32 v104, v44, v40, s68
    v_perm_b32 v105, v52, v48, s68
    v_perm_b32 v106, v60, v56, s68
    v_perm_b32 v107, v68, v64, s68
    v_perm_b32 v108, v44, v40, s69
    v_perm_b32 v109, v52, v48, s69
    v_perm_b32 v110, v60, v56, s69
    v_perm_b32 v111, v68, v64, s69
    s_nop 1
    v_mfma_f32_16x16x32_bf16 v[72:75], v[124:127], v[104:107], v[72:75]
    v_mfma_f32_16x16x32_bf16 v[76:79], v[124:127], v[108:111], v[76:79]
    v_perm_b32 v112, v45, v41, s68
    v_perm_b32 v113, v53, v49, s68
    v_perm_b32 v114, v61, v57, s68
    v_perm_b32 v115, v69, v65, s68
    v_perm_b32 v116, v45, v41, s69
    v_perm_b32 v117, v53, v49, s69
    v_perm_b32 v118, v61, v57, s69
    v_perm_b32 v119, v69, v65, s69
    s_nop 1
    v_mfma_f32_16x16x32_bf16 v[80:83], v[124:127], v[112:115], v[80:83]
    v_mfma_f32_16x16x32_bf16 v[84:87], v[124:127], v[116:119], v[84:87]
    v_perm_b32 v104, v46, v42, s68
    v_perm_b32 v105, v54, v50, s68
    v_perm_b32 v106, v62, v58, s68
    v_perm_b32 v107, v70, v66, s68
    v_perm_b32 v108, v46, v42, s69
    v_perm_b32 v109, v54, v50, s69
    v_perm_b32 v110, v62, v58, s69
    v_perm_b32 v111, v70, v66, s69
    s_nop 1
    v_mfma_f32_16x16x32_bf16 v[88:91], v[124:127], v[104:107], v[88:91]
    v_mfma_f32_16x16x32_bf16 v[92:95], v[124:127], v[108:111], v[92:95]
    v_perm_b32 v112, v47, v43, s68
    v_perm_b32 v113, v55, v51, s68
    v_perm_b32 v114, v63, v59, s68
    v_perm_b32 v115, v71, v67, s68
    v_perm_b32 v116, v47, v43, s69
    v_perm_b32 v117, v55, v51, s69
    v_perm_b32 v118, v63, v59, s69
    v_perm_b32 v119, v71, v67, s69
    s_nop 1
    v_mfma_f32_16x16x32_bf16 v[96:99], v[124:127], v[112:115], v[96:99]
    v_mfma_f32_16x16x32_bf16 v[100:103], v[124:127], v[116:119], v[100:103]
    ds_read_b128 v[40:43], v3 offset:24576
    ds_read_b128 v[44:47], v3 offset:25600
    ds_read_b128 v[48:51], v3 offset:26624
    ds_read_b128 v[52:55], v3 offset:27648
    ds_read_b128 v[56:59], v3 offset:28672
    ds_read_b128 v[60:63], v3 offset:29696
    ds_read_b128 v[64:67], v3 offset:30720
    ds_read_b128 v[68:71], v3 offset:31744
    s_waitcnt lgkmcnt(8)
    v_perm_b32 v104, v12, v8, s68
    v_perm_b32 v105, v20, v16, s68
    v_perm_b32 v106, v28, v24, s68
    v_perm_b32 v107, v36, v32, s68
    v_perm_b32 v108, v12, v8, s69
    v_perm_b32 v109, v20, v16, s69
    v_perm_b32 v110, v28, v24, s69
    v_perm_b32 v111, v36, v32, s69
    s_nop 1
    v_mfma_f32_16x16x32_bf16 v[72:75], v[128:131], v[104:107], v[72:75]
    v_mfma_f32_16x16x32_bf16 v[76:79], v[128:131], v[108:111], v[76:79]
    v_perm_b32 v112, v13, v9, s68
    v_perm_b32 v113, v21, v17, s68
    v_perm_b32 v114, v29, v25, s68
    v_perm_b32 v115, v37, v33, s68
    v_perm_b32 v116, v13, v9, s69
    v_perm_b32 v117, v21, v17, s69
    v_perm_b32 v118, v29, v25, s69
    v_perm_b32 v119, v37, v33, s69
    s_nop 1
    v_mfma_f32_16x16x32_bf16 v[80:83], v[128:131], v[112:115], v[80:83]
    v_mfma_f32_16x16x32_bf16 v[84:87], v[128:131], v[116:119], v[84:87]
    v_perm_b32 v104, v14, v10, s68
    v_perm_b32 v105, v22, v18, s68
    v_perm_b32 v106, v30, v26, s68
    v_perm_b32 v107, v38, v34, s68
    v_perm_b32 v108, v14, v10, s69
    v_perm_b32 v109, v22, v18, s69
    v_perm_b32 v110, v30, v26, s69
    v_perm_b32 v111, v38, v34, s69
    s_nop 1
    v_mfma_f32_16x16x32_bf16 v[88:91], v[128:131], v[104:107], v[88:91]
    v_mfma_f32_16x16x32_bf16 v[92:95], v[128:131], v[108:111], v[92:95]
    v_perm_b32 v112, v15, v11, s68
    v_perm_b32 v113, v23, v19, s68
    v_perm_b32 v114, v31, v27, s68
    v_perm_b32 v115, v39, v35, s68
    v_perm_b32 v116, v15, v11, s69
    v_perm_b32 v117, v23, v19, s69
    v_perm_b32 v118, v31, v27, s69
    v_perm_b32 v119, v39, v35, s69
    s_nop 1
    v_mfma_f32_16x16x32_bf16 v[96:99], v[128:131], v[112:115], v[96:99]
    v_mfma_f32_16x16x32_bf16 v[100:103], v[128:131], v[116:119], v[100:103]
    s_waitcnt lgkmcnt(0)
    v_perm_b32 v104, v44, v40, s68
    v_perm_b32 v105, v52, v48, s68
    v_perm_b32 v106, v60, v56, s68
    v_perm_b32 v107, v68, v64, s68
    v_perm_b32 v108, v44, v40, s69
    v_perm_b32 v109, v52, v48, s69
    v_perm_b32 v110, v60, v56, s69
    v_perm_b32 v111, v68, v64, s69
    s_nop 1
    v_mfma_f32_16x16x32_bf16 v[72:75], v[132:135], v[104:107], v[72:75]
    v_mfma_f32_16x16x32_bf16 v[76:79], v[132:135], v[108:111], v[76:79]
    v_perm_b32 v112, v45, v41, s68
    v_perm_b32 v113, v53, v49, s68
    v_perm_b32 v114, v61, v57, s68
    v_perm_b32 v115, v69, v65, s68
    v_perm_b32 v116, v45, v41, s69
    v_perm_b32 v117, v53, v49, s69
    v_perm_b32 v118, v61, v57, s69
    v_perm_b32 v119, v69, v65, s69
    s_nop 1
    v_mfma_f32_16x16x32_bf16 v[80:83], v[132:135], v[112:115], v[80:83]
    v_mfma_f32_16x16x32_bf16 v[84:87], v[132:135], v[116:119], v[84:87]
    v_perm_b32 v104, v46, v42, s68
    v_perm_b32 v105, v54, v50, s68
    v_perm_b32 v106, v62, v58, s68
    v_perm_b32 v107, v70, v66, s68
    v_perm_b32 v108, v46, v42, s69
    v_perm_b32 v109, v54, v50, s69
    v_perm_b32 v110, v62, v58, s69
    v_perm_b32 v111, v70, v66, s69
    s_nop 1
    v_mfma_f32_16x16x32_bf16 v[88:91], v[132:135], v[104:107], v[88:91]
    v_mfma_f32_16x16x32_bf16 v[92:95], v[132:135], v[108:111], v[92:95]
    v_perm_b32 v112, v47, v43, s68
    v_perm_b32 v113, v55, v51, s68
    v_perm_b32 v114, v63, v59, s68
    v_perm_b32 v115, v71, v67, s68
    v_perm_b32 v116, v47, v43, s69
    v_perm_b32 v117, v55, v51, s69
    v_perm_b32 v118, v63, v59, s69
    v_perm_b32 v119, v71, v67, s69
    s_nop 1
    v_mfma_f32_16x16x32_bf16 v[96:99], v[132:135], v[112:115], v[96:99]
    v_mfma_f32_16x16x32_bf16 v[100:103], v[132:135], v[116:119], v[100:103]
    s_lshl_b32 s14, s9, 16
    s_lshl_b32 s15, s8, 9
    s_add_u32 s14, s14, s15
    s_add_u32 s14, s14, 1048576
    s_lshl_b32 s15, s2, 2
    s_add_u32 s15, s15, 4096
    v_mov_b32 v136, s40
    v_mov_b32 v137, s40
    v_lshrrev_b32 v137, 8, v137
    v_mov_b32 v138, s40
    v_lshrrev_b32 v138, 16, v138
    v_mov_b32 v139, s40
    v_lshrrev_b32 v139, 24, v139
    s_nop 7
    v_bfi_b32 v8, s42, v136, v72
    v_bfi_b32 v9, s42, v137, v76
    v_bfi_b32 v10, s42, v138, v80
    v_bfi_b32 v11, s42, v139, v84
    v_bfi_b32 v12, s42, v136, v88
    v_bfi_b32 v13, s42, v137, v92
    v_bfi_b32 v14, s42, v138, v96
    v_bfi_b32 v15, s42, v139, v100
    v_bfi_b32 v16, s42, v136, v73
    v_bfi_b32 v17, s42, v137, v77
    v_bfi_b32 v18, s42, v138, v81
    v_bfi_b32 v19, s42, v139, v85
    v_bfi_b32 v20, s42, v136, v89
    v_bfi_b32 v21, s42, v137, v93
    v_bfi_b32 v22, s42, v138, v97
    v_bfi_b32 v23, s42, v139, v101
    v_bfi_b32 v24, s42, v136, v74
    v_bfi_b32 v25, s42, v137, v78
    v_bfi_b32 v26, s42, v138, v82
    v_bfi_b32 v27, s42, v139, v86
    v_bfi_b32 v28, s42, v136, v90
    v_bfi_b32 v29, s42, v137, v94
    v_bfi_b32 v30, s42, v138, v98
    v_bfi_b32 v31, s42, v139, v102
    v_bfi_b32 v32, s42, v136, v75
    v_bfi_b32 v33, s42, v137, v79
    v_bfi_b32 v34, s42, v138, v83
    v_bfi_b32 v35, s42, v139, v87
    v_bfi_b32 v36, s42, v136, v91
    v_bfi_b32 v37, s42, v137, v95
    v_bfi_b32 v38, s42, v138, v99
    v_bfi_b32 v39, s42, v139, v103
    v_lshlrev_b32 v2, 4, v0
    s_mov_b64 exec, 0xffff
    s_add_u32 s5, s14, 0
    buffer_store_dwordx4 v[8:11], v2, s[56:59], s5 offen sc1
    buffer_store_dwordx4 v[12:15], v2, s[56:59], s5 offen offset:256 sc1
    s_add_u32 s5, s14, 16384
    buffer_store_dwordx4 v[16:19], v2, s[56:59], s5 offen sc1
    buffer_store_dwordx4 v[20:23], v2, s[56:59], s5 offen offset:256 sc1
    s_add_u32 s5, s14, 32768
    buffer_store_dwordx4 v[24:27], v2, s[56:59], s5 offen sc1
    buffer_store_dwordx4 v[28:31], v2, s[56:59], s5 offen offset:256 sc1
    s_add_u32 s5, s14, 49152
    buffer_store_dwordx4 v[32:35], v2, s[56:59], s5 offen sc1
    buffer_store_dwordx4 v[36:39], v2, s[56:59], s5 offen offset:256 sc1
    s_mov_b64 exec, 1
    v_mov_b32 v2, 0
    s_mov_b64 exec, -1
    s_lshr_b32 s8, s96, 3
    s_and_b32 s9, s96, 7
    s_mov_b32 s52, s24
    s_mov_b32 s53, s25
    s_mov_b32 s54, 8388608
    s_mov_b32 s55, 0x00020000
    v_lshrrev_b32 v2, 4, v0
    s_mov_b32 s5, 16384
    v_mul_lo_u32 v2, v2, s5
    v_and_b32 v1, 15, v0
    v_lshlrev_b32 v1, 4, v1
    v_add_u32 v1, v1, v2
    s_lshl_b32 s12, s8, 16
    s_add_u32 s12, s12, 4194304
    v_lshlrev_b32 v6, 10, v0
    v_add_u32 v6, 512, v6
    s_lshl_b32 s10, s8, 8
    s_add_u32 s10, s10, 32768
    v_lshlrev_b32 v7, 2, v0
    s_mov_b32 s41, 400000
    v_mov_b32 v3, 0
L_lw_11:
    ds_read_b32 v2, v3 offset:8
    s_waitcnt lgkmcnt(0)
    v_readfirstlane_b32 s4, v2
    s_nop 3
    s_cmp_ge_u32 s4, 8
    s_cbranch_scc1 L_lwd_12
    s_sleep 1
    s_sub_u32 s41, s41, 1
    s_cmp_lg_u32 s41, 0
    s_cbranch_scc1 L_lw_11
L_lwd_12:
    s_mov_b64 exec, 1
    v_mov_b32 v2, 0
    v_mov_b32 v3, 1
    ds_add_u32 v2, v3 offset:16
    s_mov_b64 exec, -1
    s_mul_i32 s11, s8, 262144
    s_lshl_b32 s13, s9, 8
    s_add_u32 s11, s11, s13
    s_add_u32 s5, s11, 0
    s_mov_b32 m0, 40960
    s_nop 0
    buffer_load_dwordx4 v1, s[52:55], s5 offen nt lds
    s_add_u32 s5, s11, 2048
    s_mov_b32 m0, 41984
    s_nop 0
    buffer_load_dwordx4 v1, s[52:55], s5 offen nt lds
    s_add_u32 s5, s11, 4096
    s_mov_b32 m0, 43008
    s_nop 0
    buffer_load_dwordx4 v1, s[52:55], s5 offen nt lds
    s_add_u32 s5, s11, 6144
    s_mov_b32 m0, 44032
    s_nop 0
    buffer_load_dwordx4 v1, s[52:55], s5 offen nt lds
    s_add_u32 s5, s11, 8192
    s_mov_b32 m0, 45056
    s_nop 0
    buffer_load_dwordx4 v1, s[52:55], s5 offen nt lds
    s_add_u32 s5, s11, 10240
    s_mov_b32 m0, 46080
    s_nop 0
    buffer_load_dwordx4 v1, s[52:55], s5 offen nt lds
    s_add_u32 s5, s11, 12288
    s_mov_b32 m0, 47104
    s_nop 0
    buffer_load_dwordx4 v1, s[52:55], s5 offen nt lds
    s_add_u32 s5, s11, 14336
    s_mov_b32 m0, 48128
    s_nop 0
    buffer_load_dwordx4 v1, s[52:55], s5 offen nt lds
    s_add_u32 s5, s11, 65536
    s_mov_b32 m0, 49152
    s_nop 0
    buffer_load_dwordx4 v1, s[52:55], s5 offen nt lds
    s_add_u32 s5, s11, 67584
    s_mov_b32 m0, 50176
    s_nop 0
    buffer_load_dwordx4 v1, s[52:55], s5 offen nt lds
    s_add_u32 s5, s11, 69632
    s_mov_b32 m0, 51200
    s_nop 0
    buffer_load_dwordx4 v1, s[52:55], s5 offen nt lds
    s_add_u32 s5, s11, 71680
    s_mov_b32 m0, 52224
    s_nop 0
    buffer_load_dwordx4 v1, s[52:55], s5 offen nt lds
    s_add_u32 s5, s11, 73728
    s_mov_b32 m0, 53248
    s_nop 0
    buffer_load_dwordx4 v1, s[52:55], s5 offen nt lds
    s_add_u32 s5, s11, 75776
    s_mov_b32 m0, 54272
    s_nop 0
    buffer_load_dwordx4 v1, s[52:55], s5 offen nt lds
    s_add_u32 s5, s11, 77824
    s_mov_b32 m0, 55296
    s_nop 0
    buffer_load_dwordx4 v1, s[52:55], s5 offen nt lds
    s_add_u32 s5, s11, 79872
    s_mov_b32 m0, 56320
    s_nop 0
    buffer_load_dwordx4 v1, s[52:55], s5 offen nt lds
    s_add_u32 s5, s11, 131072
    s_mov_b32 m0, 57344
    s_nop 0
    buffer_load_dwordx4 v1, s[52:55], s5 offen nt lds
    s_add_u32 s5, s11, 133120
    s_mov_b32 m0, 58368
    s_nop 0
    buffer_load_dwordx4 v1, s[52:55], s5 offen nt lds
    s_add_u32 s5, s11, 135168
    s_mov_b32 m0, 59392
    s_nop 0
    buffer_load_dwordx4 v1, s[52:55], s5 offen nt lds
    s_add_u32 s5, s11, 137216
    s_mov_b32 m0, 60416
    s_nop 0
    buffer_load_dwordx4 v1, s[52:55], s5 offen nt lds
    s_add_u32 s5, s11, 139264
    s_mov_b32 m0, 61440
    s_nop 0
    buffer_load_dwordx4 v1, s[52:55], s5 offen nt lds
    s_add_u32 s5, s11, 141312
    s_mov_b32 m0, 62464
    s_nop 0
    buffer_load_dwordx4 v1, s[52:55], s5 offen nt lds
    s_add_u32 s5, s11, 143360
    s_mov_b32 m0, 63488
    s_nop 0
    buffer_load_dwordx4 v1, s[52:55], s5 offen nt lds
    s_add_u32 s5, s11, 145408
    s_mov_b32 m0, 64512
    s_nop 0
    buffer_load_dwordx4 v1, s[52:55], s5 offen nt lds
    s_add_u32 s5, s11, 196608
    s_mov_b32 m0, 65536
    s_nop 0
    buffer_load_dwordx4 v1, s[52:55], s5 offen nt lds
    s_add_u32 s5, s11, 198656
    s_mov_b32 m0, 66560
    s_nop 0
    buffer_load_dwordx4 v1, s[52:55], s5 offen nt lds
    s_add_u32 s5, s11, 200704
    s_mov_b32 m0, 67584
    s_nop 0
    buffer_load_dwordx4 v1, s[52:55], s5 offen nt lds
    s_add_u32 s5, s11, 202752
    s_mov_b32 m0, 68608
    s_nop 0
    buffer_load_dwordx4 v1, s[52:55], s5 offen nt lds
    s_add_u32 s5, s11, 204800
    s_mov_b32 m0, 69632
    s_nop 0
    buffer_load_dwordx4 v1, s[52:55], s5 offen nt lds
    s_add_u32 s5, s11, 206848
    s_mov_b32 m0, 70656
    s_nop 0
    buffer_load_dwordx4 v1, s[52:55], s5 offen nt lds
    s_add_u32 s5, s11, 208896
    s_mov_b32 m0, 71680
    s_nop 0
    buffer_load_dwordx4 v1, s[52:55], s5 offen nt lds
    s_add_u32 s5, s11, 210944
    s_mov_b32 m0, 72704
    s_nop 0
    buffer_load_dwordx4 v1, s[52:55], s5 offen nt lds
    s_mov_b32 s41, 400000
    v_mov_b32 v3, 0
L_lw_13:
    ds_read_b32 v2, v3 offset:20
    s_waitcnt lgkmcnt(0)
    v_readfirstlane_b32 s4, v2
    s_nop 3
    s_cmp_ge_u32 s4, 8
    s_cbranch_scc1 L_lwd_14
    s_sleep 1
    s_sub_u32 s41, s41, 1
    s_cmp_lg_u32 s41, 0
    s_cbranch_scc1 L_lw_13
L_lwd_14:
    s_mov_b32 s41, 100000
L_pl_15:
    buffer_load_dwordx4 v[136:139], v6, s[56:59], s12 offen sc1
    s_waitcnt vmcnt(0)
    v_cmp_ne_u32 vcc, s40, v138
    s_nop 3
    s_cmp_eq_u64 vcc, 0
    s_cbranch_scc1 L_pld_16
    s_sleep 4
    s_sub_u32 s41, s41, 1
    s_cmp_lg_u32 s41, 0
    s_cbranch_scc1 L_pl_15
L_pld_16:
    v_mov_b32 v138, v136
    s_nop 1
    v_max_f32_dpp v138, v138, v138 row_ror:8 row_mask:0xf bank_mask:0xf
    s_nop 1
    v_max_f32_dpp v138, v138, v138 row_ror:4 row_mask:0xf bank_mask:0xf
    s_nop 1
    v_max_f32_dpp v138, v138, v138 row_ror:2 row_mask:0xf bank_mask:0xf
    s_nop 1
    v_max_f32_dpp v138, v138, v138 row_ror:1 row_mask:0xf bank_mask:0xf
    v_sub_f32 v136, v136, v138
    v_exp_f32 v136, v136
    s_nop 0
    v_mul_f32 v137, v136, v137
    s_nop 1
    v_add_f32_dpp v137, v137, v137 row_ror:8 row_mask:0xf bank_mask:0xf
    s_nop 1
    v_add_f32_dpp v137, v137, v137 row_ror:4 row_mask:0xf bank_mask:0xf
    s_nop 1
    v_add_f32_dpp v137, v137, v137 row_ror:2 row_mask:0xf bank_mask:0xf
    s_nop 1
    v_add_f32_dpp v137, v137, v137 row_ror:1 row_mask:0xf bank_mask:0xf
    v_rcp_f32 v137, v137
    s_nop 0
    v_mul_f32 v136, v136, v137
    v_lshrrev_b32 v2, 4, v0
    v_lshlrev_b32 v2, 14, v2
    v_and_b32 v3, 15, v0
    v_lshl_add_u32 v2, v3, 5, v2
    v_mov_b32_dpp v140, v136 row_newbcast:0 row_mask:0xf bank_mask:0xf
    v_mov_b32_dpp v141, v136 row_newbcast:1 row_mask:0xf bank_mask:0xf
    v_mov_b32_dpp v142, v136 row_newbcast:2 row_mask:0xf bank_mask:0xf
    v_mov_b32_dpp v143, v136 row_newbcast:3 row_mask:0xf bank_mask:0xf
    v_mov_b32_dpp v144, v136 row_newbcast:4 row_mask:0xf bank_mask:0xf
    v_mov_b32_dpp v145, v136 row_newbcast:5 row_mask:0xf bank_mask:0xf
    v_mov_b32_dpp v146, v136 row_newbcast:6 row_mask:0xf bank_mask:0xf
    v_mov_b32_dpp v147, v136 row_newbcast:7 row_mask:0xf bank_mask:0xf
    v_mov_b32_dpp v148, v136 row_newbcast:8 row_mask:0xf bank_mask:0xf
    v_mov_b32_dpp v149, v136 row_newbcast:9 row_mask:0xf bank_mask:0xf
    v_mov_b32_dpp v150, v136 row_newbcast:10 row_mask:0xf bank_mask:0xf
    v_mov_b32_dpp v151, v136 row_newbcast:11 row_mask:0xf bank_mask:0xf
    v_mov_b32_dpp v152, v136 row_newbcast:12 row_mask:0xf bank_mask:0xf
    v_mov_b32_dpp v153, v136 row_newbcast:13 row_mask:0xf bank_mask:0xf
    v_mov_b32_dpp v154, v136 row_newbcast:14 row_mask:0xf bank_mask:0xf
    v_mov_b32_dpp v155, v136 row_newbcast:15 row_mask:0xf bank_mask:0xf
    s_add_u32 s5, s12, 0
    buffer_load_dwordx4 v[8:11], v2, s[56:59], s5 offen
    buffer_load_dwordx4 v[12:15], v2, s[56:59], s5 offen offset:16
    s_add_u32 s5, s12, 1024
    buffer_load_dwordx4 v[16:19], v2, s[56:59], s5 offen
    buffer_load_dwordx4 v[20:23], v2, s[56:59], s5 offen offset:16
    s_add_u32 s5, s12, 2048
    buffer_load_dwordx4 v[24:27], v2, s[56:59], s5 offen
    buffer_load_dwordx4 v[28:31], v2, s[56:59], s5 offen offset:16
    s_add_u32 s5, s12, 3072
    buffer_load_dwordx4 v[32:35], v2, s[56:59], s5 offen
    buffer_load_dwordx4 v[36:39], v2, s[56:59], s5 offen offset:16
    s_add_u32 s5, s12, 4096
    buffer_load_dwordx4 v[40:43], v2, s[56:59], s5 offen
    buffer_load_dwordx4 v[44:47], v2, s[56:59], s5 offen offset:16
    s_add_u32 s5, s12, 5120
    buffer_load_dwordx4 v[48:51], v2, s[56:59], s5 offen
    buffer_load_dwordx4 v[52:55], v2, s[56:59], s5 offen offset:16
    s_add_u32 s5, s12, 6144
    buffer_load_dwordx4 v[56:59], v2, s[56:59], s5 offen
    buffer_load_dwordx4 v[60:63], v2, s[56:59], s5 offen offset:16
    s_add_u32 s5, s12, 7168
    buffer_load_dwordx4 v[64:67], v2, s[56:59], s5 offen
    buffer_load_dwordx4 v[68:71], v2, s[56:59], s5 offen offset:16
    s_add_u32 s5, s12, 8192
    buffer_load_dwordx4 v[72:75], v2, s[56:59], s5 offen
    buffer_load_dwordx4 v[76:79], v2, s[56:59], s5 offen offset:16
    s_add_u32 s5, s12, 9216
    buffer_load_dwordx4 v[80:83], v2, s[56:59], s5 offen
    buffer_load_dwordx4 v[84:87], v2, s[56:59], s5 offen offset:16
    s_add_u32 s5, s12, 10240
    buffer_load_dwordx4 v[88:91], v2, s[56:59], s5 offen
    buffer_load_dwordx4 v[92:95], v2, s[56:59], s5 offen offset:16
    s_add_u32 s5, s12, 11264
    buffer_load_dwordx4 v[96:99], v2, s[56:59], s5 offen
    buffer_load_dwordx4 v[100:103], v2, s[56:59], s5 offen offset:16
    s_add_u32 s5, s12, 12288
    buffer_load_dwordx4 v[104:107], v2, s[56:59], s5 offen
    buffer_load_dwordx4 v[108:111], v2, s[56:59], s5 offen offset:16
    s_add_u32 s5, s12, 13312
    buffer_load_dwordx4 v[112:115], v2, s[56:59], s5 offen
    buffer_load_dwordx4 v[116:119], v2, s[56:59], s5 offen offset:16
    s_add_u32 s5, s12, 14336
    buffer_load_dwordx4 v[120:123], v2, s[56:59], s5 offen
    buffer_load_dwordx4 v[124:127], v2, s[56:59], s5 offen offset:16
    s_add_u32 s5, s12, 15360
    buffer_load_dwordx4 v[128:131], v2, s[56:59], s5 offen
    buffer_load_dwordx4 v[132:135], v2, s[56:59], s5 offen offset:16
    s_waitcnt vmcnt(31)
    v_perm_b32 v137, v9, v8, s43
    v_perm_b32 v138, v11, v10, s88
    v_or_b32 v137, v137, v138
    v_xor_b32 v136, s40, v137
    s_waitcnt vmcnt(30)
    v_perm_b32 v137, v13, v12, s43
    v_perm_b32 v138, v15, v14, s88
    v_or_b32 v137, v137, v138
    v_xor_b32 v137, s40, v137
    v_or_b32 v136, v136, v137
    s_waitcnt vmcnt(29)
    v_perm_b32 v137, v17, v16, s43
    v_perm_b32 v138, v19, v18, s88
    v_or_b32 v137, v137, v138
    v_xor_b32 v137, s40, v137
    v_or_b32 v136, v136, v137
    s_waitcnt vmcnt(28)
    v_perm_b32 v137, v21, v20, s43
    v_perm_b32 v138, v23, v22, s88
    v_or_b32 v137, v137, v138
    v_xor_b32 v137, s40, v137
    v_or_b32 v136, v136, v137
    s_waitcnt vmcnt(27)
    v_perm_b32 v137, v25, v24, s43
    v_perm_b32 v138, v27, v26, s88
    v_or_b32 v137, v137, v138
    v_xor_b32 v137, s40, v137
    v_or_b32 v136, v136, v137
    s_waitcnt vmcnt(26)
    v_perm_b32 v137, v29, v28, s43
    v_perm_b32 v138, v31, v30, s88
    v_or_b32 v137, v137, v138
    v_xor_b32 v137, s40, v137
    v_or_b32 v136, v136, v137
    s_waitcnt vmcnt(25)
    v_perm_b32 v137, v33, v32, s43
    v_perm_b32 v138, v35, v34, s88
    v_or_b32 v137, v137, v138
    v_xor_b32 v137, s40, v137
    v_or_b32 v136, v136, v137
    s_waitcnt vmcnt(24)
    v_perm_b32 v137, v37, v36, s43
    v_perm_b32 v138, v39, v38, s88
    v_or_b32 v137, v137, v138
    v_xor_b32 v137, s40, v137
    v_or_b32 v136, v136, v137
    s_waitcnt vmcnt(23)
    v_perm_b32 v137, v41, v40, s43
    v_perm_b32 v138, v43, v42, s88
    v_or_b32 v137, v137, v138
    v_xor_b32 v137, s40, v137
    v_or_b32 v136, v136, v137
    s_waitcnt vmcnt(22)
    v_perm_b32 v137, v45, v44, s43
    v_perm_b32 v138, v47, v46, s88
    v_or_b32 v137, v137, v138
    v_xor_b32 v137, s40, v137
    v_or_b32 v136, v136, v137
    s_waitcnt vmcnt(21)
    v_perm_b32 v137, v49, v48, s43
    v_perm_b32 v138, v51, v50, s88
    v_or_b32 v137, v137, v138
    v_xor_b32 v137, s40, v137
    v_or_b32 v136, v136, v137
    s_waitcnt vmcnt(20)
    v_perm_b32 v137, v53, v52, s43
    v_perm_b32 v138, v55, v54, s88
    v_or_b32 v137, v137, v138
    v_xor_b32 v137, s40, v137
    v_or_b32 v136, v136, v137
    s_waitcnt vmcnt(19)
    v_perm_b32 v137, v57, v56, s43
    v_perm_b32 v138, v59, v58, s88
    v_or_b32 v137, v137, v138
    v_xor_b32 v137, s40, v137
    v_or_b32 v136, v136, v137
    s_waitcnt vmcnt(18)
    v_perm_b32 v137, v61, v60, s43
    v_perm_b32 v138, v63, v62, s88
    v_or_b32 v137, v137, v138
    v_xor_b32 v137, s40, v137
    v_or_b32 v136, v136, v137
    s_waitcnt vmcnt(17)
    v_perm_b32 v137, v65, v64, s43
    v_perm_b32 v138, v67, v66, s88
    v_or_b32 v137, v137, v138
    v_xor_b32 v137, s40, v137
    v_or_b32 v136, v136, v137
    s_waitcnt vmcnt(16)
    v_perm_b32 v137, v69, v68, s43
    v_perm_b32 v138, v71, v70, s88
    v_or_b32 v137, v137, v138
    v_xor_b32 v137, s40, v137
    v_or_b32 v136, v136, v137
    s_waitcnt vmcnt(15)
    v_perm_b32 v137, v73, v72, s43
    v_perm_b32 v138, v75, v74, s88
    v_or_b32 v137, v137, v138
    v_xor_b32 v137, s40, v137
    v_or_b32 v136, v136, v137
    s_waitcnt vmcnt(14)
    v_perm_b32 v137, v77, v76, s43
    v_perm_b32 v138, v79, v78, s88
    v_or_b32 v137, v137, v138
    v_xor_b32 v137, s40, v137
    v_or_b32 v136, v136, v137
    s_waitcnt vmcnt(13)
    v_perm_b32 v137, v81, v80, s43
    v_perm_b32 v138, v83, v82, s88
    v_or_b32 v137, v137, v138
    v_xor_b32 v137, s40, v137
    v_or_b32 v136, v136, v137
    s_waitcnt vmcnt(12)
    v_perm_b32 v137, v85, v84, s43
    v_perm_b32 v138, v87, v86, s88
    v_or_b32 v137, v137, v138
    v_xor_b32 v137, s40, v137
    v_or_b32 v136, v136, v137
    s_waitcnt vmcnt(11)
    v_perm_b32 v137, v89, v88, s43
    v_perm_b32 v138, v91, v90, s88
    v_or_b32 v137, v137, v138
    v_xor_b32 v137, s40, v137
    v_or_b32 v136, v136, v137
    s_waitcnt vmcnt(10)
    v_perm_b32 v137, v93, v92, s43
    v_perm_b32 v138, v95, v94, s88
    v_or_b32 v137, v137, v138
    v_xor_b32 v137, s40, v137
    v_or_b32 v136, v136, v137
    s_waitcnt vmcnt(9)
    v_perm_b32 v137, v97, v96, s43
    v_perm_b32 v138, v99, v98, s88
    v_or_b32 v137, v137, v138
    v_xor_b32 v137, s40, v137
    v_or_b32 v136, v136, v137
    s_waitcnt vmcnt(8)
    v_perm_b32 v137, v101, v100, s43
    v_perm_b32 v138, v103, v102, s88
    v_or_b32 v137, v137, v138
    v_xor_b32 v137, s40, v137
    v_or_b32 v136, v136, v137
    s_waitcnt vmcnt(7)
    v_perm_b32 v137, v105, v104, s43
    v_perm_b32 v138, v107, v106, s88
    v_or_b32 v137, v137, v138
    v_xor_b32 v137, s40, v137
    v_or_b32 v136, v136, v137
    s_waitcnt vmcnt(6)
    v_perm_b32 v137, v109, v108, s43
    v_perm_b32 v138, v111, v110, s88
    v_or_b32 v137, v137, v138
    v_xor_b32 v137, s40, v137
    v_or_b32 v136, v136, v137
    s_waitcnt vmcnt(5)
    v_perm_b32 v137, v113, v112, s43
    v_perm_b32 v138, v115, v114, s88
    v_or_b32 v137, v137, v138
    v_xor_b32 v137, s40, v137
    v_or_b32 v136, v136, v137
    s_waitcnt vmcnt(4)
    v_perm_b32 v137, v117, v116, s43
    v_perm_b32 v138, v119, v118, s88
    v_or_b32 v137, v137, v138
    v_xor_b32 v137, s40, v137
    v_or_b32 v136, v136, v137
    s_waitcnt vmcnt(3)
    v_perm_b32 v137, v121, v120, s43
    v_perm_b32 v138, v123, v122, s88
    v_or_b32 v137, v137, v138
    v_xor_b32 v137, s40, v137
    v_or_b32 v136, v136, v137
    s_waitcnt vmcnt(2)
    v_perm_b32 v137, v125, v124, s43
    v_perm_b32 v138, v127, v126, s88
    v_or_b32 v137, v137, v138
    v_xor_b32 v137, s40, v137
    v_or_b32 v136, v136, v137
    s_waitcnt vmcnt(1)
    v_perm_b32 v137, v129, v128, s43
    v_perm_b32 v138, v131, v130, s88
    v_or_b32 v137, v137, v138
    v_xor_b32 v137, s40, v137
    v_or_b32 v136, v136, v137
    s_waitcnt vmcnt(0)
    v_perm_b32 v137, v133, v132, s43
    v_perm_b32 v138, v135, v134, s88
    v_or_b32 v137, v137, v138
    v_xor_b32 v137, s40, v137
    v_or_b32 v136, v136, v137
    v_cmp_ne_u32 vcc, 0, v136
    s_nop 3
    s_cmp_eq_u64 vcc, 0
    s_cbranch_scc1 L_grd_18
    s_mov_b32 s41, 100000
L_gr_17:
    s_add_u32 s5, s12, 0
    buffer_load_dwordx4 v[8:11], v2, s[56:59], s5 offen sc1
    buffer_load_dwordx4 v[12:15], v2, s[56:59], s5 offen offset:16 sc1
    s_add_u32 s5, s12, 1024
    buffer_load_dwordx4 v[16:19], v2, s[56:59], s5 offen sc1
    buffer_load_dwordx4 v[20:23], v2, s[56:59], s5 offen offset:16 sc1
    s_add_u32 s5, s12, 2048
    buffer_load_dwordx4 v[24:27], v2, s[56:59], s5 offen sc1
    buffer_load_dwordx4 v[28:31], v2, s[56:59], s5 offen offset:16 sc1
    s_add_u32 s5, s12, 3072
    buffer_load_dwordx4 v[32:35], v2, s[56:59], s5 offen sc1
    buffer_load_dwordx4 v[36:39], v2, s[56:59], s5 offen offset:16 sc1
    s_add_u32 s5, s12, 4096
    buffer_load_dwordx4 v[40:43], v2, s[56:59], s5 offen sc1
    buffer_load_dwordx4 v[44:47], v2, s[56:59], s5 offen offset:16 sc1
    s_add_u32 s5, s12, 5120
    buffer_load_dwordx4 v[48:51], v2, s[56:59], s5 offen sc1
    buffer_load_dwordx4 v[52:55], v2, s[56:59], s5 offen offset:16 sc1
    s_add_u32 s5, s12, 6144
    buffer_load_dwordx4 v[56:59], v2, s[56:59], s5 offen sc1
    buffer_load_dwordx4 v[60:63], v2, s[56:59], s5 offen offset:16 sc1
    s_add_u32 s5, s12, 7168
    buffer_load_dwordx4 v[64:67], v2, s[56:59], s5 offen sc1
    buffer_load_dwordx4 v[68:71], v2, s[56:59], s5 offen offset:16 sc1
    s_add_u32 s5, s12, 8192
    buffer_load_dwordx4 v[72:75], v2, s[56:59], s5 offen sc1
    buffer_load_dwordx4 v[76:79], v2, s[56:59], s5 offen offset:16 sc1
    s_add_u32 s5, s12, 9216
    buffer_load_dwordx4 v[80:83], v2, s[56:59], s5 offen sc1
    buffer_load_dwordx4 v[84:87], v2, s[56:59], s5 offen offset:16 sc1
    s_add_u32 s5, s12, 10240
    buffer_load_dwordx4 v[88:91], v2, s[56:59], s5 offen sc1
    buffer_load_dwordx4 v[92:95], v2, s[56:59], s5 offen offset:16 sc1
    s_add_u32 s5, s12, 11264
    buffer_load_dwordx4 v[96:99], v2, s[56:59], s5 offen sc1
    buffer_load_dwordx4 v[100:103], v2, s[56:59], s5 offen offset:16 sc1
    s_add_u32 s5, s12, 12288
    buffer_load_dwordx4 v[104:107], v2, s[56:59], s5 offen sc1
    buffer_load_dwordx4 v[108:111], v2, s[56:59], s5 offen offset:16 sc1
    s_add_u32 s5, s12, 13312
    buffer_load_dwordx4 v[112:115], v2, s[56:59], s5 offen sc1
    buffer_load_dwordx4 v[116:119], v2, s[56:59], s5 offen offset:16 sc1
    s_add_u32 s5, s12, 14336
    buffer_load_dwordx4 v[120:123], v2, s[56:59], s5 offen sc1
    buffer_load_dwordx4 v[124:127], v2, s[56:59], s5 offen offset:16 sc1
    s_add_u32 s5, s12, 15360
    buffer_load_dwordx4 v[128:131], v2, s[56:59], s5 offen sc1
    buffer_load_dwordx4 v[132:135], v2, s[56:59], s5 offen offset:16 sc1
    s_waitcnt vmcnt(31)
    v_perm_b32 v137, v9, v8, s43
    v_perm_b32 v138, v11, v10, s88
    v_or_b32 v137, v137, v138
    v_xor_b32 v136, s40, v137
    s_waitcnt vmcnt(30)
    v_perm_b32 v137, v13, v12, s43
    v_perm_b32 v138, v15, v14, s88
    v_or_b32 v137, v137, v138
    v_xor_b32 v137, s40, v137
    v_or_b32 v136, v136, v137
    s_waitcnt vmcnt(29)
    v_perm_b32 v137, v17, v16, s43
    v_perm_b32 v138, v19, v18, s88
    v_or_b32 v137, v137, v138
    v_xor_b32 v137, s40, v137
    v_or_b32 v136, v136, v137
    s_waitcnt vmcnt(28)
    v_perm_b32 v137, v21, v20, s43
    v_perm_b32 v138, v23, v22, s88
    v_or_b32 v137, v137, v138
    v_xor_b32 v137, s40, v137
    v_or_b32 v136, v136, v137
    s_waitcnt vmcnt(27)
    v_perm_b32 v137, v25, v24, s43
    v_perm_b32 v138, v27, v26, s88
    v_or_b32 v137, v137, v138
    v_xor_b32 v137, s40, v137
    v_or_b32 v136, v136, v137
    s_waitcnt vmcnt(26)
    v_perm_b32 v137, v29, v28, s43
    v_perm_b32 v138, v31, v30, s88
    v_or_b32 v137, v137, v138
    v_xor_b32 v137, s40, v137
    v_or_b32 v136, v136, v137
    s_waitcnt vmcnt(25)
    v_perm_b32 v137, v33, v32, s43
    v_perm_b32 v138, v35, v34, s88
    v_or_b32 v137, v137, v138
    v_xor_b32 v137, s40, v137
    v_or_b32 v136, v136, v137
    s_waitcnt vmcnt(24)
    v_perm_b32 v137, v37, v36, s43
    v_perm_b32 v138, v39, v38, s88
    v_or_b32 v137, v137, v138
    v_xor_b32 v137, s40, v137
    v_or_b32 v136, v136, v137
    s_waitcnt vmcnt(23)
    v_perm_b32 v137, v41, v40, s43
    v_perm_b32 v138, v43, v42, s88
    v_or_b32 v137, v137, v138
    v_xor_b32 v137, s40, v137
    v_or_b32 v136, v136, v137
    s_waitcnt vmcnt(22)
    v_perm_b32 v137, v45, v44, s43
    v_perm_b32 v138, v47, v46, s88
    v_or_b32 v137, v137, v138
    v_xor_b32 v137, s40, v137
    v_or_b32 v136, v136, v137
    s_waitcnt vmcnt(21)
    v_perm_b32 v137, v49, v48, s43
    v_perm_b32 v138, v51, v50, s88
    v_or_b32 v137, v137, v138
    v_xor_b32 v137, s40, v137
    v_or_b32 v136, v136, v137
    s_waitcnt vmcnt(20)
    v_perm_b32 v137, v53, v52, s43
    v_perm_b32 v138, v55, v54, s88
    v_or_b32 v137, v137, v138
    v_xor_b32 v137, s40, v137
    v_or_b32 v136, v136, v137
    s_waitcnt vmcnt(19)
    v_perm_b32 v137, v57, v56, s43
    v_perm_b32 v138, v59, v58, s88
    v_or_b32 v137, v137, v138
    v_xor_b32 v137, s40, v137
    v_or_b32 v136, v136, v137
    s_waitcnt vmcnt(18)
    v_perm_b32 v137, v61, v60, s43
    v_perm_b32 v138, v63, v62, s88
    v_or_b32 v137, v137, v138
    v_xor_b32 v137, s40, v137
    v_or_b32 v136, v136, v137
    s_waitcnt vmcnt(17)
    v_perm_b32 v137, v65, v64, s43
    v_perm_b32 v138, v67, v66, s88
    v_or_b32 v137, v137, v138
    v_xor_b32 v137, s40, v137
    v_or_b32 v136, v136, v137
    s_waitcnt vmcnt(16)
    v_perm_b32 v137, v69, v68, s43
    v_perm_b32 v138, v71, v70, s88
    v_or_b32 v137, v137, v138
    v_xor_b32 v137, s40, v137
    v_or_b32 v136, v136, v137
    s_waitcnt vmcnt(15)
    v_perm_b32 v137, v73, v72, s43
    v_perm_b32 v138, v75, v74, s88
    v_or_b32 v137, v137, v138
    v_xor_b32 v137, s40, v137
    v_or_b32 v136, v136, v137
    s_waitcnt vmcnt(14)
    v_perm_b32 v137, v77, v76, s43
    v_perm_b32 v138, v79, v78, s88
    v_or_b32 v137, v137, v138
    v_xor_b32 v137, s40, v137
    v_or_b32 v136, v136, v137
    s_waitcnt vmcnt(13)
    v_perm_b32 v137, v81, v80, s43
    v_perm_b32 v138, v83, v82, s88
    v_or_b32 v137, v137, v138
    v_xor_b32 v137, s40, v137
    v_or_b32 v136, v136, v137
    s_waitcnt vmcnt(12)
    v_perm_b32 v137, v85, v84, s43
    v_perm_b32 v138, v87, v86, s88
    v_or_b32 v137, v137, v138
    v_xor_b32 v137, s40, v137
    v_or_b32 v136, v136, v137
    s_waitcnt vmcnt(11)
    v_perm_b32 v137, v89, v88, s43
    v_perm_b32 v138, v91, v90, s88
    v_or_b32 v137, v137, v138
    v_xor_b32 v137, s40, v137
    v_or_b32 v136, v136, v137
    s_waitcnt vmcnt(10)
    v_perm_b32 v137, v93, v92, s43
    v_perm_b32 v138, v95, v94, s88
    v_or_b32 v137, v137, v138
    v_xor_b32 v137, s40, v137
    v_or_b32 v136, v136, v137
    s_waitcnt vmcnt(9)
    v_perm_b32 v137, v97, v96, s43
    v_perm_b32 v138, v99, v98, s88
    v_or_b32 v137, v137, v138
    v_xor_b32 v137, s40, v137
    v_or_b32 v136, v136, v137
    s_waitcnt vmcnt(8)
    v_perm_b32 v137, v101, v100, s43
    v_perm_b32 v138, v103, v102, s88
    v_or_b32 v137, v137, v138
    v_xor_b32 v137, s40, v137
    v_or_b32 v136, v136, v137
    s_waitcnt vmcnt(7)
    v_perm_b32 v137, v105, v104, s43
    v_perm_b32 v138, v107, v106, s88
    v_or_b32 v137, v137, v138
    v_xor_b32 v137, s40, v137
    v_or_b32 v136, v136, v137
    s_waitcnt vmcnt(6)
    v_perm_b32 v137, v109, v108, s43
    v_perm_b32 v138, v111, v110, s88
    v_or_b32 v137, v137, v138
    v_xor_b32 v137, s40, v137
    v_or_b32 v136, v136, v137
    s_waitcnt vmcnt(5)
    v_perm_b32 v137, v113, v112, s43
    v_perm_b32 v138, v115, v114, s88
    v_or_b32 v137, v137, v138
    v_xor_b32 v137, s40, v137
    v_or_b32 v136, v136, v137
    s_waitcnt vmcnt(4)
    v_perm_b32 v137, v117, v116, s43
    v_perm_b32 v138, v119, v118, s88
    v_or_b32 v137, v137, v138
    v_xor_b32 v137, s40, v137
    v_or_b32 v136, v136, v137
    s_waitcnt vmcnt(3)
    v_perm_b32 v137, v121, v120, s43
    v_perm_b32 v138, v123, v122, s88
    v_or_b32 v137, v137, v138
    v_xor_b32 v137, s40, v137
    v_or_b32 v136, v136, v137
    s_waitcnt vmcnt(2)
    v_perm_b32 v137, v125, v124, s43
    v_perm_b32 v138, v127, v126, s88
    v_or_b32 v137, v137, v138
    v_xor_b32 v137, s40, v137
    v_or_b32 v136, v136, v137
    s_waitcnt vmcnt(1)
    v_perm_b32 v137, v129, v128, s43
    v_perm_b32 v138, v131, v130, s88
    v_or_b32 v137, v137, v138
    v_xor_b32 v137, s40, v137
    v_or_b32 v136, v136, v137
    s_waitcnt vmcnt(0)
    v_perm_b32 v137, v133, v132, s43
    v_perm_b32 v138, v135, v134, s88
    v_or_b32 v137, v137, v138
    v_xor_b32 v137, s40, v137
    v_or_b32 v136, v136, v137
    v_cmp_ne_u32 vcc, 0, v136
    s_nop 3
    s_cmp_eq_u64 vcc, 0
    s_cbranch_scc1 L_grd_18
    s_sleep 2
    s_sub_u32 s41, s41, 1
    s_cmp_lg_u32 s41, 0
    s_cbranch_scc1 L_gr_17
L_grd_18:
    v_mul_f32 v8, v8, v140
    v_mul_f32 v9, v9, v140
    v_mul_f32 v10, v10, v140
    v_mul_f32 v11, v11, v140
    v_mul_f32 v12, v12, v140
    v_mul_f32 v13, v13, v140
    v_mul_f32 v14, v14, v140
    v_mul_f32 v15, v15, v140
    v_fmac_f32 v8, v16, v141
    v_fmac_f32 v9, v17, v141
    v_fmac_f32 v10, v18, v141
    v_fmac_f32 v11, v19, v141
    v_fmac_f32 v12, v20, v141
    v_fmac_f32 v13, v21, v141
    v_fmac_f32 v14, v22, v141
    v_fmac_f32 v15, v23, v141
    v_fmac_f32 v8, v24, v142
    v_fmac_f32 v9, v25, v142
    v_fmac_f32 v10, v26, v142
    v_fmac_f32 v11, v27, v142
    v_fmac_f32 v12, v28, v142
    v_fmac_f32 v13, v29, v142
    v_fmac_f32 v14, v30, v142
    v_fmac_f32 v15, v31, v142
    v_fmac_f32 v8, v32, v143
    v_fmac_f32 v9, v33, v143
    v_fmac_f32 v10, v34, v143
    v_fmac_f32 v11, v35, v143
    v_fmac_f32 v12, v36, v143
    v_fmac_f32 v13, v37, v143
    v_fmac_f32 v14, v38, v143
    v_fmac_f32 v15, v39, v143
    v_fmac_f32 v8, v40, v144
    v_fmac_f32 v9, v41, v144
    v_fmac_f32 v10, v42, v144
    v_fmac_f32 v11, v43, v144
    v_fmac_f32 v12, v44, v144
    v_fmac_f32 v13, v45, v144
    v_fmac_f32 v14, v46, v144
    v_fmac_f32 v15, v47, v144
    v_fmac_f32 v8, v48, v145
    v_fmac_f32 v9, v49, v145
    v_fmac_f32 v10, v50, v145
    v_fmac_f32 v11, v51, v145
    v_fmac_f32 v12, v52, v145
    v_fmac_f32 v13, v53, v145
    v_fmac_f32 v14, v54, v145
    v_fmac_f32 v15, v55, v145
    v_fmac_f32 v8, v56, v146
    v_fmac_f32 v9, v57, v146
    v_fmac_f32 v10, v58, v146
    v_fmac_f32 v11, v59, v146
    v_fmac_f32 v12, v60, v146
    v_fmac_f32 v13, v61, v146
    v_fmac_f32 v14, v62, v146
    v_fmac_f32 v15, v63, v146
    v_fmac_f32 v8, v64, v147
    v_fmac_f32 v9, v65, v147
    v_fmac_f32 v10, v66, v147
    v_fmac_f32 v11, v67, v147
    v_fmac_f32 v12, v68, v147
    v_fmac_f32 v13, v69, v147
    v_fmac_f32 v14, v70, v147
    v_fmac_f32 v15, v71, v147
    v_fmac_f32 v8, v72, v148
    v_fmac_f32 v9, v73, v148
    v_fmac_f32 v10, v74, v148
    v_fmac_f32 v11, v75, v148
    v_fmac_f32 v12, v76, v148
    v_fmac_f32 v13, v77, v148
    v_fmac_f32 v14, v78, v148
    v_fmac_f32 v15, v79, v148
    v_fmac_f32 v8, v80, v149
    v_fmac_f32 v9, v81, v149
    v_fmac_f32 v10, v82, v149
    v_fmac_f32 v11, v83, v149
    v_fmac_f32 v12, v84, v149
    v_fmac_f32 v13, v85, v149
    v_fmac_f32 v14, v86, v149
    v_fmac_f32 v15, v87, v149
    v_fmac_f32 v8, v88, v150
    v_fmac_f32 v9, v89, v150
    v_fmac_f32 v10, v90, v150
    v_fmac_f32 v11, v91, v150
    v_fmac_f32 v12, v92, v150
    v_fmac_f32 v13, v93, v150
    v_fmac_f32 v14, v94, v150
    v_fmac_f32 v15, v95, v150
    v_fmac_f32 v8, v96, v151
    v_fmac_f32 v9, v97, v151
    v_fmac_f32 v10, v98, v151
    v_fmac_f32 v11, v99, v151
    v_fmac_f32 v12, v100, v151
    v_fmac_f32 v13, v101, v151
    v_fmac_f32 v14, v102, v151
    v_fmac_f32 v15, v103, v151
    v_fmac_f32 v8, v104, v152
    v_fmac_f32 v9, v105, v152
    v_fmac_f32 v10, v106, v152
    v_fmac_f32 v11, v107, v152
    v_fmac_f32 v12, v108, v152
    v_fmac_f32 v13, v109, v152
    v_fmac_f32 v14, v110, v152
    v_fmac_f32 v15, v111, v152
    v_fmac_f32 v8, v112, v153
    v_fmac_f32 v9, v113, v153
    v_fmac_f32 v10, v114, v153
    v_fmac_f32 v11, v115, v153
    v_fmac_f32 v12, v116, v153
    v_fmac_f32 v13, v117, v153
    v_fmac_f32 v14, v118, v153
    v_fmac_f32 v15, v119, v153
    v_fmac_f32 v8, v120, v154
    v_fmac_f32 v9, v121, v154
    v_fmac_f32 v10, v122, v154
    v_fmac_f32 v11, v123, v154
    v_fmac_f32 v12, v124, v154
    v_fmac_f32 v13, v125, v154
    v_fmac_f32 v14, v126, v154
    v_fmac_f32 v15, v127, v154
    v_fmac_f32 v8, v128, v155
    v_fmac_f32 v9, v129, v155
    v_fmac_f32 v10, v130, v155
    v_fmac_f32 v11, v131, v155
    v_fmac_f32 v12, v132, v155
    v_fmac_f32 v13, v133, v155
    v_fmac_f32 v14, v134, v155
    v_fmac_f32 v15, v135, v155
    v_cvt_pk_bf16_f32 v24, v8, v9
    v_cvt_pk_bf16_f32 v25, v10, v11
    v_cvt_pk_bf16_f32 v26, v12, v13
    v_cvt_pk_bf16_f32 v27, v14, v15
    v_lshlrev_b32 v2, 4, v0
    ds_write_b128 v2, v[24:27] offset:3072
    v_and_b32 v2, 3, v0
    v_lshlrev_b32 v2, 8, v2
    v_lshrrev_b32 v3, 4, v0
    v_lshlrev_b32 v3, 4, v3
    v_add_u32 v2, v2, v3
    s_waitcnt lgkmcnt(0)
    ds_read_b128 v[120:123], v2 offset:3072
    ds_read_b128 v[124:127], v2 offset:3136
    ds_read_b128 v[128:131], v2 offset:3200
    ds_read_b128 v[132:135], v2 offset:3264
    s_waitcnt lgkmcnt(0)
    v_lshlrev_b32 v2, 4, v0
    v_add_u32 v3, 40960, v2
    ds_read_b128 v[8:11], v3 offset:0
    ds_read_b128 v[12:15], v3 offset:1024
    ds_read_b128 v[16:19], v3 offset:2048
    ds_read_b128 v[20:23], v3 offset:3072
    ds_read_b128 v[24:27], v3 offset:4096
    ds_read_b128 v[28:31], v3 offset:5120
    ds_read_b128 v[32:35], v3 offset:6144
    ds_read_b128 v[36:39], v3 offset:7168
    ds_read_b128 v[40:43], v3 offset:8192
    ds_read_b128 v[44:47], v3 offset:9216
    ds_read_b128 v[48:51], v3 offset:10240
    ds_read_b128 v[52:55], v3 offset:11264
    ds_read_b128 v[56:59], v3 offset:12288
    ds_read_b128 v[60:63], v3 offset:13312
    ds_read_b128 v[64:67], v3 offset:14336
    ds_read_b128 v[68:71], v3 offset:15360
    s_waitcnt lgkmcnt(8)
    v_perm_b32 v104, v12, v8, s68
    v_perm_b32 v105, v20, v16, s68
    v_perm_b32 v106, v28, v24, s68
    v_perm_b32 v107, v36, v32, s68
    v_perm_b32 v108, v12, v8, s69
    v_perm_b32 v109, v20, v16, s69
    v_perm_b32 v110, v28, v24, s69
    v_perm_b32 v111, v36, v32, s69
    s_nop 1
    v_mfma_f32_16x16x32_bf16 v[72:75], v[120:123], v[104:107], 0
    v_mfma_f32_16x16x32_bf16 v[76:79], v[120:123], v[108:111], 0
    v_perm_b32 v112, v13, v9, s68
    v_perm_b32 v113, v21, v17, s68
    v_perm_b32 v114, v29, v25, s68
    v_perm_b32 v115, v37, v33, s68
    v_perm_b32 v116, v13, v9, s69
    v_perm_b32 v117, v21, v17, s69
    v_perm_b32 v118, v29, v25, s69
    v_perm_b32 v119, v37, v33, s69
    s_nop 1
    v_mfma_f32_16x16x32_bf16 v[80:83], v[120:123], v[112:115], 0
    v_mfma_f32_16x16x32_bf16 v[84:87], v[120:123], v[116:119], 0
    v_perm_b32 v104, v14, v10, s68
    v_perm_b32 v105, v22, v18, s68
    v_perm_b32 v106, v30, v26, s68
    v_perm_b32 v107, v38, v34, s68
    v_perm_b32 v108, v14, v10, s69
    v_perm_b32 v109, v22, v18, s69
    v_perm_b32 v110, v30, v26, s69
    v_perm_b32 v111, v38, v34, s69
    s_nop 1
    v_mfma_f32_16x16x32_bf16 v[88:91], v[120:123], v[104:107], 0
    v_mfma_f32_16x16x32_bf16 v[92:95], v[120:123], v[108:111], 0
    v_perm_b32 v112, v15, v11, s68
    v_perm_b32 v113, v23, v19, s68
    v_perm_b32 v114, v31, v27, s68
    v_perm_b32 v115, v39, v35, s68
    v_perm_b32 v116, v15, v11, s69
    v_perm_b32 v117, v23, v19, s69
    v_perm_b32 v118, v31, v27, s69
    v_perm_b32 v119, v39, v35, s69
    s_nop 1
    v_mfma_f32_16x16x32_bf16 v[96:99], v[120:123], v[112:115], 0
    v_mfma_f32_16x16x32_bf16 v[100:103], v[120:123], v[116:119], 0
    ds_read_b128 v[8:11], v3 offset:16384
    ds_read_b128 v[12:15], v3 offset:17408
    ds_read_b128 v[16:19], v3 offset:18432
    ds_read_b128 v[20:23], v3 offset:19456
    ds_read_b128 v[24:27], v3 offset:20480
    ds_read_b128 v[28:31], v3 offset:21504
    ds_read_b128 v[32:35], v3 offset:22528
    ds_read_b128 v[36:39], v3 offset:23552
    s_waitcnt lgkmcnt(8)
    v_perm_b32 v104, v44, v40, s68
    v_perm_b32 v105, v52, v48, s68
    v_perm_b32 v106, v60, v56, s68
    v_perm_b32 v107, v68, v64, s68
    v_perm_b32 v108, v44, v40, s69
    v_perm_b32 v109, v52, v48, s69
    v_perm_b32 v110, v60, v56, s69
    v_perm_b32 v111, v68, v64, s69
    s_nop 1
    v_mfma_f32_16x16x32_bf16 v[72:75], v[124:127], v[104:107], v[72:75]
    v_mfma_f32_16x16x32_bf16 v[76:79], v[124:127], v[108:111], v[76:79]
    v_perm_b32 v112, v45, v41, s68
    v_perm_b32 v113, v53, v49, s68
    v_perm_b32 v114, v61, v57, s68
    v_perm_b32 v115, v69, v65, s68
    v_perm_b32 v116, v45, v41, s69
    v_perm_b32 v117, v53, v49, s69
    v_perm_b32 v118, v61, v57, s69
    v_perm_b32 v119, v69, v65, s69
    s_nop 1
    v_mfma_f32_16x16x32_bf16 v[80:83], v[124:127], v[112:115], v[80:83]
    v_mfma_f32_16x16x32_bf16 v[84:87], v[124:127], v[116:119], v[84:87]
    v_perm_b32 v104, v46, v42, s68
    v_perm_b32 v105, v54, v50, s68
    v_perm_b32 v106, v62, v58, s68
    v_perm_b32 v107, v70, v66, s68
    v_perm_b32 v108, v46, v42, s69
    v_perm_b32 v109, v54, v50, s69
    v_perm_b32 v110, v62, v58, s69
    v_perm_b32 v111, v70, v66, s69
    s_nop 1
    v_mfma_f32_16x16x32_bf16 v[88:91], v[124:127], v[104:107], v[88:91]
    v_mfma_f32_16x16x32_bf16 v[92:95], v[124:127], v[108:111], v[92:95]
    v_perm_b32 v112, v47, v43, s68
    v_perm_b32 v113, v55, v51, s68
    v_perm_b32 v114, v63, v59, s68
    v_perm_b32 v115, v71, v67, s68
    v_perm_b32 v116, v47, v43, s69
    v_perm_b32 v117, v55, v51, s69
    v_perm_b32 v118, v63, v59, s69
    v_perm_b32 v119, v71, v67, s69
    s_nop 1
    v_mfma_f32_16x16x32_bf16 v[96:99], v[124:127], v[112:115], v[96:99]
    v_mfma_f32_16x16x32_bf16 v[100:103], v[124:127], v[116:119], v[100:103]
    ds_read_b128 v[40:43], v3 offset:24576
    ds_read_b128 v[44:47], v3 offset:25600
    ds_read_b128 v[48:51], v3 offset:26624
    ds_read_b128 v[52:55], v3 offset:27648
    ds_read_b128 v[56:59], v3 offset:28672
    ds_read_b128 v[60:63], v3 offset:29696
    ds_read_b128 v[64:67], v3 offset:30720
    ds_read_b128 v[68:71], v3 offset:31744
    s_waitcnt lgkmcnt(8)
    v_perm_b32 v104, v12, v8, s68
    v_perm_b32 v105, v20, v16, s68
    v_perm_b32 v106, v28, v24, s68
    v_perm_b32 v107, v36, v32, s68
    v_perm_b32 v108, v12, v8, s69
    v_perm_b32 v109, v20, v16, s69
    v_perm_b32 v110, v28, v24, s69
    v_perm_b32 v111, v36, v32, s69
    s_nop 1
    v_mfma_f32_16x16x32_bf16 v[72:75], v[128:131], v[104:107], v[72:75]
    v_mfma_f32_16x16x32_bf16 v[76:79], v[128:131], v[108:111], v[76:79]
    v_perm_b32 v112, v13, v9, s68
    v_perm_b32 v113, v21, v17, s68
    v_perm_b32 v114, v29, v25, s68
    v_perm_b32 v115, v37, v33, s68
    v_perm_b32 v116, v13, v9, s69
    v_perm_b32 v117, v21, v17, s69
    v_perm_b32 v118, v29, v25, s69
    v_perm_b32 v119, v37, v33, s69
    s_nop 1
    v_mfma_f32_16x16x32_bf16 v[80:83], v[128:131], v[112:115], v[80:83]
    v_mfma_f32_16x16x32_bf16 v[84:87], v[128:131], v[116:119], v[84:87]
    v_perm_b32 v104, v14, v10, s68
    v_perm_b32 v105, v22, v18, s68
    v_perm_b32 v106, v30, v26, s68
    v_perm_b32 v107, v38, v34, s68
    v_perm_b32 v108, v14, v10, s69
    v_perm_b32 v109, v22, v18, s69
    v_perm_b32 v110, v30, v26, s69
    v_perm_b32 v111, v38, v34, s69
    s_nop 1
    v_mfma_f32_16x16x32_bf16 v[88:91], v[128:131], v[104:107], v[88:91]
    v_mfma_f32_16x16x32_bf16 v[92:95], v[128:131], v[108:111], v[92:95]
    v_perm_b32 v112, v15, v11, s68
    v_perm_b32 v113, v23, v19, s68
    v_perm_b32 v114, v31, v27, s68
    v_perm_b32 v115, v39, v35, s68
    v_perm_b32 v116, v15, v11, s69
    v_perm_b32 v117, v23, v19, s69
    v_perm_b32 v118, v31, v27, s69
    v_perm_b32 v119, v39, v35, s69
    s_nop 1
    v_mfma_f32_16x16x32_bf16 v[96:99], v[128:131], v[112:115], v[96:99]
    v_mfma_f32_16x16x32_bf16 v[100:103], v[128:131], v[116:119], v[100:103]
    s_waitcnt lgkmcnt(0)
    v_perm_b32 v104, v44, v40, s68
    v_perm_b32 v105, v52, v48, s68
    v_perm_b32 v106, v60, v56, s68
    v_perm_b32 v107, v68, v64, s68
    v_perm_b32 v108, v44, v40, s69
    v_perm_b32 v109, v52, v48, s69
    v_perm_b32 v110, v60, v56, s69
    v_perm_b32 v111, v68, v64, s69
    s_nop 1
    v_mfma_f32_16x16x32_bf16 v[72:75], v[132:135], v[104:107], v[72:75]
    v_mfma_f32_16x16x32_bf16 v[76:79], v[132:135], v[108:111], v[76:79]
    v_perm_b32 v112, v45, v41, s68
    v_perm_b32 v113, v53, v49, s68
    v_perm_b32 v114, v61, v57, s68
    v_perm_b32 v115, v69, v65, s68
    v_perm_b32 v116, v45, v41, s69
    v_perm_b32 v117, v53, v49, s69
    v_perm_b32 v118, v61, v57, s69
    v_perm_b32 v119, v69, v65, s69
    s_nop 1
    v_mfma_f32_16x16x32_bf16 v[80:83], v[132:135], v[112:115], v[80:83]
    v_mfma_f32_16x16x32_bf16 v[84:87], v[132:135], v[116:119], v[84:87]
    v_perm_b32 v104, v46, v42, s68
    v_perm_b32 v105, v54, v50, s68
    v_perm_b32 v106, v62, v58, s68
    v_perm_b32 v107, v70, v66, s68
    v_perm_b32 v108, v46, v42, s69
    v_perm_b32 v109, v54, v50, s69
    v_perm_b32 v110, v62, v58, s69
    v_perm_b32 v111, v70, v66, s69
    s_nop 1
    v_mfma_f32_16x16x32_bf16 v[88:91], v[132:135], v[104:107], v[88:91]
    v_mfma_f32_16x16x32_bf16 v[92:95], v[132:135], v[108:111], v[92:95]
    v_perm_b32 v112, v47, v43, s68
    v_perm_b32 v113, v55, v51, s68
    v_perm_b32 v114, v63, v59, s68
    v_perm_b32 v115, v71, v67, s68
    v_perm_b32 v116, v47, v43, s69
    v_perm_b32 v117, v55, v51, s69
    v_perm_b32 v118, v63, v59, s69
    v_perm_b32 v119, v71, v67, s69
    s_nop 1
    v_mfma_f32_16x16x32_bf16 v[96:99], v[132:135], v[112:115], v[96:99]
    v_mfma_f32_16x16x32_bf16 v[100:103], v[132:135], v[116:119], v[100:103]
    s_lshl_b32 s14, s9, 17
    s_lshl_b32 s12, s8, 11
    s_add_u32 s14, s14, s12
    s_add_u32 s14, s14, 8388608
    s_lshl_b32 s12, s9, 6
    s_add_u32 s15, s8, s12
    s_lshl_b32 s15, s15, 2
    s_add_u32 s15, s15, 12288
    s_mul_i32 s4, s40, 0x9e3779b1
    s_lshr_b32 s4, s4, 16
    v_mov_b32 v136, s40
    v_lshrrev_b32 v137, 12, v136
    s_lshr_b32 s5, s40, 24
    s_lshl_b32 s6, s4, 8
    s_or_b32 s5, s5, s6
    v_mov_b32 v138, s5
    s_lshr_b32 s4, s4, 4
    v_mov_b32 v139, s4
    s_nop 7
    v_bfi_b32 v8, s89, v136, v72
    v_bfi_b32 v9, s89, v137, v76
    v_bfi_b32 v10, s89, v138, v80
    v_bfi_b32 v11, s89, v139, v84
    v_bfi_b32 v12, s89, v136, v88
    v_bfi_b32 v13, s89, v137, v92
    v_bfi_b32 v14, s89, v138, v96
    v_bfi_b32 v15, s89, v139, v100
    v_bfi_b32 v16, s89, v136, v73
    v_bfi_b32 v17, s89, v137, v77
    v_bfi_b32 v18, s89, v138, v81
    v_bfi_b32 v19, s89, v139, v85
    v_bfi_b32 v20, s89, v136, v89
    v_bfi_b32 v21, s89, v137, v93
    v_bfi_b32 v22, s89, v138, v97
    v_bfi_b32 v23, s89, v139, v101
    v_bfi_b32 v24, s89, v136, v74
    v_bfi_b32 v25, s89, v137, v78
    v_bfi_b32 v26, s89, v138, v82
    v_bfi_b32 v27, s89, v139, v86
    v_bfi_b32 v28, s89, v136, v90
    v_bfi_b32 v29, s89, v137, v94
    v_bfi_b32 v30, s89, v138, v98
    v_bfi_b32 v31, s89, v139, v102
    v_bfi_b32 v32, s89, v136, v75
    v_bfi_b32 v33, s89, v137, v79
    v_bfi_b32 v34, s89, v138, v83
    v_bfi_b32 v35, s89, v139, v87
    v_bfi_b32 v36, s89, v136, v91
    v_bfi_b32 v37, s89, v137, v95
    v_bfi_b32 v38, s89, v138, v99
    v_bfi_b32 v39, s89, v139, v103
    v_lshlrev_b32 v2, 4, v0
    s_mov_b64 exec, 0xffff
    s_add_u32 s5, s14, 0
    buffer_store_dwordx4 v[8:11], v2, s[56:59], s5 offen sc1
    buffer_store_dwordx4 v[12:15], v2, s[56:59], s5 offen offset:256 sc1
    s_add_u32 s5, s14, 512
    buffer_store_dwordx4 v[16:19], v2, s[56:59], s5 offen sc1
    buffer_store_dwordx4 v[20:23], v2, s[56:59], s5 offen offset:256 sc1
    s_add_u32 s5, s14, 1024
    buffer_store_dwordx4 v[24:27], v2, s[56:59], s5 offen sc1
    buffer_store_dwordx4 v[28:31], v2, s[56:59], s5 offen offset:256 sc1
    s_add_u32 s5, s14, 1536
    buffer_store_dwordx4 v[32:35], v2, s[56:59], s5 offen sc1
    buffer_store_dwordx4 v[36:39], v2, s[56:59], s5 offen offset:256 sc1
    s_mov_b64 exec, 1
    v_mov_b32 v2, 0
    s_mov_b64 exec, -1
    s_endpgm
L_comm:
    v_mov_b32 v2, 0
    v_lshlrev_b32 v3, 2, v0
    ds_write_b32 v3, v2
    s_waitcnt lgkmcnt(0)
    s_barrier
    s_add_u32 s40, s40, 1
    s_lshr_b32 s8, s96, 4
    s_and_b32 s8, s8, 3
    s_lshr_b32 s9, s96, 6
    s_lshl_b32 s12, s8, 8
    s_add_u32 s12, s12, 4096
    s_mov_b32 s41, 400000
    v_mov_b32 v3, 0
L_lw_19:
    ds_read_b32 v2, v3 offset:24
    s_waitcnt lgkmcnt(0)
    v_readfirstlane_b32 s4, v2
    s_nop 3
    s_cmp_ge_u32 s4, 4
    s_cbranch_scc1 L_lwd_20
    s_sleep 1
    s_sub_u32 s41, s41, 1
    s_cmp_lg_u32 s41, 0
    s_cbranch_scc1 L_lw_19
L_lwd_20:
    s_lshl_b32 s12, s9, 14
    s_lshl_b32 s13, s8, 12
    s_add_u32 s12, s12, s13
    s_add_u32 s12, s12, 1048576
    v_lshlrev_b32 v2, 4, v0
    s_add_u32 s5, s12, 0
    buffer_load_dwordx4 v[8:11], v2, s[56:59], s5 offen offset:0
    buffer_load_dwordx4 v[12:15], v2, s[56:59], s5 offen offset:1024
    buffer_load_dwordx4 v[16:19], v2, s[56:59], s5 offen offset:2048
    buffer_load_dwordx4 v[20:23], v2, s[56:59], s5 offen offset:3072
    s_add_u32 s5, s12, 65536
    buffer_load_dwordx4 v[24:27], v2, s[56:59], s5 offen offset:0
    buffer_load_dwordx4 v[28:31], v2, s[56:59], s5 offen offset:1024
    buffer_load_dwordx4 v[32:35], v2, s[56:59], s5 offen offset:2048
    buffer_load_dwordx4 v[36:39], v2, s[56:59], s5 offen offset:3072
    s_add_u32 s5, s12, 131072
    buffer_load_dwordx4 v[40:43], v2, s[56:59], s5 offen offset:0
    buffer_load_dwordx4 v[44:47], v2, s[56:59], s5 offen offset:1024
    buffer_load_dwordx4 v[48:51], v2, s[56:59], s5 offen offset:2048
    buffer_load_dwordx4 v[52:55], v2, s[56:59], s5 offen offset:3072
    s_add_u32 s5, s12, 196608
    buffer_load_dwordx4 v[56:59], v2, s[56:59], s5 offen offset:0
    buffer_load_dwordx4 v[60:63], v2, s[56:59], s5 offen offset:1024
    buffer_load_dwordx4 v[64:67], v2, s[56:59], s5 offen offset:2048
    buffer_load_dwordx4 v[68:71], v2, s[56:59], s5 offen offset:3072
    s_add_u32 s5, s12, 262144
    buffer_load_dwordx4 v[72:75], v2, s[56:59], s5 offen offset:0
    buffer_load_dwordx4 v[76:79], v2, s[56:59], s5 offen offset:1024
    buffer_load_dwordx4 v[80:83], v2, s[56:59], s5 offen offset:2048
    buffer_load_dwordx4 v[84:87], v2, s[56:59], s5 offen offset:3072
    s_add_u32 s5, s12, 327680
    buffer_load_dwordx4 v[88:91], v2, s[56:59], s5 offen offset:0
    buffer_load_dwordx4 v[92:95], v2, s[56:59], s5 offen offset:1024
    buffer_load_dwordx4 v[96:99], v2, s[56:59], s5 offen offset:2048
    buffer_load_dwordx4 v[100:103], v2, s[56:59], s5 offen offset:3072
    s_add_u32 s5, s12, 393216
    buffer_load_dwordx4 v[104:107], v2, s[56:59], s5 offen offset:0
    buffer_load_dwordx4 v[108:111], v2, s[56:59], s5 offen offset:1024
    buffer_load_dwordx4 v[112:115], v2, s[56:59], s5 offen offset:2048
    buffer_load_dwordx4 v[116:119], v2, s[56:59], s5 offen offset:3072
    s_add_u32 s5, s12, 458752
    buffer_load_dwordx4 v[120:123], v2, s[56:59], s5 offen offset:0
    buffer_load_dwordx4 v[124:127], v2, s[56:59], s5 offen offset:1024
    buffer_load_dwordx4 v[128:131], v2, s[56:59], s5 offen offset:2048
    buffer_load_dwordx4 v[132:135], v2, s[56:59], s5 offen offset:3072
    s_waitcnt vmcnt(31)
    v_perm_b32 v137, v9, v8, s43
    v_perm_b32 v138, v11, v10, s88
    v_or_b32 v137, v137, v138
    v_xor_b32 v136, s40, v137
    s_waitcnt vmcnt(30)
    v_perm_b32 v137, v13, v12, s43
    v_perm_b32 v138, v15, v14, s88
    v_or_b32 v137, v137, v138
    v_xor_b32 v137, s40, v137
    v_or_b32 v136, v136, v137
    s_waitcnt vmcnt(29)
    v_perm_b32 v137, v17, v16, s43
    v_perm_b32 v138, v19, v18, s88
    v_or_b32 v137, v137, v138
    v_xor_b32 v137, s40, v137
    v_or_b32 v136, v136, v137
    s_waitcnt vmcnt(28)
    v_perm_b32 v137, v21, v20, s43
    v_perm_b32 v138, v23, v22, s88
    v_or_b32 v137, v137, v138
    v_xor_b32 v137, s40, v137
    v_or_b32 v136, v136, v137
    s_waitcnt vmcnt(27)
    v_perm_b32 v137, v25, v24, s43
    v_perm_b32 v138, v27, v26, s88
    v_or_b32 v137, v137, v138
    v_xor_b32 v137, s40, v137
    v_or_b32 v136, v136, v137
    s_waitcnt vmcnt(26)
    v_perm_b32 v137, v29, v28, s43
    v_perm_b32 v138, v31, v30, s88
    v_or_b32 v137, v137, v138
    v_xor_b32 v137, s40, v137
    v_or_b32 v136, v136, v137
    s_waitcnt vmcnt(25)
    v_perm_b32 v137, v33, v32, s43
    v_perm_b32 v138, v35, v34, s88
    v_or_b32 v137, v137, v138
    v_xor_b32 v137, s40, v137
    v_or_b32 v136, v136, v137
    s_waitcnt vmcnt(24)
    v_perm_b32 v137, v37, v36, s43
    v_perm_b32 v138, v39, v38, s88
    v_or_b32 v137, v137, v138
    v_xor_b32 v137, s40, v137
    v_or_b32 v136, v136, v137
    s_waitcnt vmcnt(23)
    v_perm_b32 v137, v41, v40, s43
    v_perm_b32 v138, v43, v42, s88
    v_or_b32 v137, v137, v138
    v_xor_b32 v137, s40, v137
    v_or_b32 v136, v136, v137
    s_waitcnt vmcnt(22)
    v_perm_b32 v137, v45, v44, s43
    v_perm_b32 v138, v47, v46, s88
    v_or_b32 v137, v137, v138
    v_xor_b32 v137, s40, v137
    v_or_b32 v136, v136, v137
    s_waitcnt vmcnt(21)
    v_perm_b32 v137, v49, v48, s43
    v_perm_b32 v138, v51, v50, s88
    v_or_b32 v137, v137, v138
    v_xor_b32 v137, s40, v137
    v_or_b32 v136, v136, v137
    s_waitcnt vmcnt(20)
    v_perm_b32 v137, v53, v52, s43
    v_perm_b32 v138, v55, v54, s88
    v_or_b32 v137, v137, v138
    v_xor_b32 v137, s40, v137
    v_or_b32 v136, v136, v137
    s_waitcnt vmcnt(19)
    v_perm_b32 v137, v57, v56, s43
    v_perm_b32 v138, v59, v58, s88
    v_or_b32 v137, v137, v138
    v_xor_b32 v137, s40, v137
    v_or_b32 v136, v136, v137
    s_waitcnt vmcnt(18)
    v_perm_b32 v137, v61, v60, s43
    v_perm_b32 v138, v63, v62, s88
    v_or_b32 v137, v137, v138
    v_xor_b32 v137, s40, v137
    v_or_b32 v136, v136, v137
    s_waitcnt vmcnt(17)
    v_perm_b32 v137, v65, v64, s43
    v_perm_b32 v138, v67, v66, s88
    v_or_b32 v137, v137, v138
    v_xor_b32 v137, s40, v137
    v_or_b32 v136, v136, v137
    s_waitcnt vmcnt(16)
    v_perm_b32 v137, v69, v68, s43
    v_perm_b32 v138, v71, v70, s88
    v_or_b32 v137, v137, v138
    v_xor_b32 v137, s40, v137
    v_or_b32 v136, v136, v137
    s_waitcnt vmcnt(15)
    v_perm_b32 v137, v73, v72, s43
    v_perm_b32 v138, v75, v74, s88
    v_or_b32 v137, v137, v138
    v_xor_b32 v137, s40, v137
    v_or_b32 v136, v136, v137
    s_waitcnt vmcnt(14)
    v_perm_b32 v137, v77, v76, s43
    v_perm_b32 v138, v79, v78, s88
    v_or_b32 v137, v137, v138
    v_xor_b32 v137, s40, v137
    v_or_b32 v136, v136, v137
    s_waitcnt vmcnt(13)
    v_perm_b32 v137, v81, v80, s43
    v_perm_b32 v138, v83, v82, s88
    v_or_b32 v137, v137, v138
    v_xor_b32 v137, s40, v137
    v_or_b32 v136, v136, v137
    s_waitcnt vmcnt(12)
    v_perm_b32 v137, v85, v84, s43
    v_perm_b32 v138, v87, v86, s88
    v_or_b32 v137, v137, v138
    v_xor_b32 v137, s40, v137
    v_or_b32 v136, v136, v137
    s_waitcnt vmcnt(11)
    v_perm_b32 v137, v89, v88, s43
    v_perm_b32 v138, v91, v90, s88
    v_or_b32 v137, v137, v138
    v_xor_b32 v137, s40, v137
    v_or_b32 v136, v136, v137
    s_waitcnt vmcnt(10)
    v_perm_b32 v137, v93, v92, s43
    v_perm_b32 v138, v95, v94, s88
    v_or_b32 v137, v137, v138
    v_xor_b32 v137, s40, v137
    v_or_b32 v136, v136, v137
    s_waitcnt vmcnt(9)
    v_perm_b32 v137, v97, v96, s43
    v_perm_b32 v138, v99, v98, s88
    v_or_b32 v137, v137, v138
    v_xor_b32 v137, s40, v137
    v_or_b32 v136, v136, v137
    s_waitcnt vmcnt(8)
    v_perm_b32 v137, v101, v100, s43
    v_perm_b32 v138, v103, v102, s88
    v_or_b32 v137, v137, v138
    v_xor_b32 v137, s40, v137
    v_or_b32 v136, v136, v137
    s_waitcnt vmcnt(7)
    v_perm_b32 v137, v105, v104, s43
    v_perm_b32 v138, v107, v106, s88
    v_or_b32 v137, v137, v138
    v_xor_b32 v137, s40, v137
    v_or_b32 v136, v136, v137
    s_waitcnt vmcnt(6)
    v_perm_b32 v137, v109, v108, s43
    v_perm_b32 v138, v111, v110, s88
    v_or_b32 v137, v137, v138
    v_xor_b32 v137, s40, v137
    v_or_b32 v136, v136, v137
    s_waitcnt vmcnt(5)
    v_perm_b32 v137, v113, v112, s43
    v_perm_b32 v138, v115, v114, s88
    v_or_b32 v137, v137, v138
    v_xor_b32 v137, s40, v137
    v_or_b32 v136, v136, v137
    s_waitcnt vmcnt(4)
    v_perm_b32 v137, v117, v116, s43
    v_perm_b32 v138, v119, v118, s88
    v_or_b32 v137, v137, v138
    v_xor_b32 v137, s40, v137
    v_or_b32 v136, v136, v137
    s_waitcnt vmcnt(3)
    v_perm_b32 v137, v121, v120, s43
    v_perm_b32 v138, v123, v122, s88
    v_or_b32 v137, v137, v138
    v_xor_b32 v137, s40, v137
    v_or_b32 v136, v136, v137
    s_waitcnt vmcnt(2)
    v_perm_b32 v137, v125, v124, s43
    v_perm_b32 v138, v127, v126, s88
    v_or_b32 v137, v137, v138
    v_xor_b32 v137, s40, v137
    v_or_b32 v136, v136, v137
    s_waitcnt vmcnt(1)
    v_perm_b32 v137, v129, v128, s43
    v_perm_b32 v138, v131, v130, s88
    v_or_b32 v137, v137, v138
    v_xor_b32 v137, s40, v137
    v_or_b32 v136, v136, v137
    s_waitcnt vmcnt(0)
    v_perm_b32 v137, v133, v132, s43
    v_perm_b32 v138, v135, v134, s88
    v_or_b32 v137, v137, v138
    v_xor_b32 v137, s40, v137
    v_or_b32 v136, v136, v137
    v_cmp_ne_u32 vcc, 0, v136
    s_nop 3
    s_cmp_eq_u64 vcc, 0
    s_cbranch_scc1 L_grd_22
    s_mov_b32 s41, 100000
L_gr_21:
    s_add_u32 s5, s12, 0
    buffer_load_dwordx4 v[8:11], v2, s[56:59], s5 offen offset:0 sc1
    buffer_load_dwordx4 v[12:15], v2, s[56:59], s5 offen offset:1024 sc1
    buffer_load_dwordx4 v[16:19], v2, s[56:59], s5 offen offset:2048 sc1
    buffer_load_dwordx4 v[20:23], v2, s[56:59], s5 offen offset:3072 sc1
    s_add_u32 s5, s12, 65536
    buffer_load_dwordx4 v[24:27], v2, s[56:59], s5 offen offset:0 sc1
    buffer_load_dwordx4 v[28:31], v2, s[56:59], s5 offen offset:1024 sc1
    buffer_load_dwordx4 v[32:35], v2, s[56:59], s5 offen offset:2048 sc1
    buffer_load_dwordx4 v[36:39], v2, s[56:59], s5 offen offset:3072 sc1
    s_add_u32 s5, s12, 131072
    buffer_load_dwordx4 v[40:43], v2, s[56:59], s5 offen offset:0 sc1
    buffer_load_dwordx4 v[44:47], v2, s[56:59], s5 offen offset:1024 sc1
    buffer_load_dwordx4 v[48:51], v2, s[56:59], s5 offen offset:2048 sc1
    buffer_load_dwordx4 v[52:55], v2, s[56:59], s5 offen offset:3072 sc1
    s_add_u32 s5, s12, 196608
    buffer_load_dwordx4 v[56:59], v2, s[56:59], s5 offen offset:0 sc1
    buffer_load_dwordx4 v[60:63], v2, s[56:59], s5 offen offset:1024 sc1
    buffer_load_dwordx4 v[64:67], v2, s[56:59], s5 offen offset:2048 sc1
    buffer_load_dwordx4 v[68:71], v2, s[56:59], s5 offen offset:3072 sc1
    s_add_u32 s5, s12, 262144
    buffer_load_dwordx4 v[72:75], v2, s[56:59], s5 offen offset:0 sc1
    buffer_load_dwordx4 v[76:79], v2, s[56:59], s5 offen offset:1024 sc1
    buffer_load_dwordx4 v[80:83], v2, s[56:59], s5 offen offset:2048 sc1
    buffer_load_dwordx4 v[84:87], v2, s[56:59], s5 offen offset:3072 sc1
    s_add_u32 s5, s12, 327680
    buffer_load_dwordx4 v[88:91], v2, s[56:59], s5 offen offset:0 sc1
    buffer_load_dwordx4 v[92:95], v2, s[56:59], s5 offen offset:1024 sc1
    buffer_load_dwordx4 v[96:99], v2, s[56:59], s5 offen offset:2048 sc1
    buffer_load_dwordx4 v[100:103], v2, s[56:59], s5 offen offset:3072 sc1
    s_add_u32 s5, s12, 393216
    buffer_load_dwordx4 v[104:107], v2, s[56:59], s5 offen offset:0 sc1
    buffer_load_dwordx4 v[108:111], v2, s[56:59], s5 offen offset:1024 sc1
    buffer_load_dwordx4 v[112:115], v2, s[56:59], s5 offen offset:2048 sc1
    buffer_load_dwordx4 v[116:119], v2, s[56:59], s5 offen offset:3072 sc1
    s_add_u32 s5, s12, 458752
    buffer_load_dwordx4 v[120:123], v2, s[56:59], s5 offen offset:0 sc1
    buffer_load_dwordx4 v[124:127], v2, s[56:59], s5 offen offset:1024 sc1
    buffer_load_dwordx4 v[128:131], v2, s[56:59], s5 offen offset:2048 sc1
    buffer_load_dwordx4 v[132:135], v2, s[56:59], s5 offen offset:3072 sc1
    s_waitcnt vmcnt(31)
    v_perm_b32 v137, v9, v8, s43
    v_perm_b32 v138, v11, v10, s88
    v_or_b32 v137, v137, v138
    v_xor_b32 v136, s40, v137
    s_waitcnt vmcnt(30)
    v_perm_b32 v137, v13, v12, s43
    v_perm_b32 v138, v15, v14, s88
    v_or_b32 v137, v137, v138
    v_xor_b32 v137, s40, v137
    v_or_b32 v136, v136, v137
    s_waitcnt vmcnt(29)
    v_perm_b32 v137, v17, v16, s43
    v_perm_b32 v138, v19, v18, s88
    v_or_b32 v137, v137, v138
    v_xor_b32 v137, s40, v137
    v_or_b32 v136, v136, v137
    s_waitcnt vmcnt(28)
    v_perm_b32 v137, v21, v20, s43
    v_perm_b32 v138, v23, v22, s88
    v_or_b32 v137, v137, v138
    v_xor_b32 v137, s40, v137
    v_or_b32 v136, v136, v137
    s_waitcnt vmcnt(27)
    v_perm_b32 v137, v25, v24, s43
    v_perm_b32 v138, v27, v26, s88
    v_or_b32 v137, v137, v138
    v_xor_b32 v137, s40, v137
    v_or_b32 v136, v136, v137
    s_waitcnt vmcnt(26)
    v_perm_b32 v137, v29, v28, s43
    v_perm_b32 v138, v31, v30, s88
    v_or_b32 v137, v137, v138
    v_xor_b32 v137, s40, v137
    v_or_b32 v136, v136, v137
    s_waitcnt vmcnt(25)
    v_perm_b32 v137, v33, v32, s43
    v_perm_b32 v138, v35, v34, s88
    v_or_b32 v137, v137, v138
    v_xor_b32 v137, s40, v137
    v_or_b32 v136, v136, v137
    s_waitcnt vmcnt(24)
    v_perm_b32 v137, v37, v36, s43
    v_perm_b32 v138, v39, v38, s88
    v_or_b32 v137, v137, v138
    v_xor_b32 v137, s40, v137
    v_or_b32 v136, v136, v137
    s_waitcnt vmcnt(23)
    v_perm_b32 v137, v41, v40, s43
    v_perm_b32 v138, v43, v42, s88
    v_or_b32 v137, v137, v138
    v_xor_b32 v137, s40, v137
    v_or_b32 v136, v136, v137
    s_waitcnt vmcnt(22)
    v_perm_b32 v137, v45, v44, s43
    v_perm_b32 v138, v47, v46, s88
    v_or_b32 v137, v137, v138
    v_xor_b32 v137, s40, v137
    v_or_b32 v136, v136, v137
    s_waitcnt vmcnt(21)
    v_perm_b32 v137, v49, v48, s43
    v_perm_b32 v138, v51, v50, s88
    v_or_b32 v137, v137, v138
    v_xor_b32 v137, s40, v137
    v_or_b32 v136, v136, v137
    s_waitcnt vmcnt(20)
    v_perm_b32 v137, v53, v52, s43
    v_perm_b32 v138, v55, v54, s88
    v_or_b32 v137, v137, v138
    v_xor_b32 v137, s40, v137
    v_or_b32 v136, v136, v137
    s_waitcnt vmcnt(19)
    v_perm_b32 v137, v57, v56, s43
    v_perm_b32 v138, v59, v58, s88
    v_or_b32 v137, v137, v138
    v_xor_b32 v137, s40, v137
    v_or_b32 v136, v136, v137
    s_waitcnt vmcnt(18)
    v_perm_b32 v137, v61, v60, s43
    v_perm_b32 v138, v63, v62, s88
    v_or_b32 v137, v137, v138
    v_xor_b32 v137, s40, v137
    v_or_b32 v136, v136, v137
    s_waitcnt vmcnt(17)
    v_perm_b32 v137, v65, v64, s43
    v_perm_b32 v138, v67, v66, s88
    v_or_b32 v137, v137, v138
    v_xor_b32 v137, s40, v137
    v_or_b32 v136, v136, v137
    s_waitcnt vmcnt(16)
    v_perm_b32 v137, v69, v68, s43
    v_perm_b32 v138, v71, v70, s88
    v_or_b32 v137, v137, v138
    v_xor_b32 v137, s40, v137
    v_or_b32 v136, v136, v137
    s_waitcnt vmcnt(15)
    v_perm_b32 v137, v73, v72, s43
    v_perm_b32 v138, v75, v74, s88
    v_or_b32 v137, v137, v138
    v_xor_b32 v137, s40, v137
    v_or_b32 v136, v136, v137
    s_waitcnt vmcnt(14)
    v_perm_b32 v137, v77, v76, s43
    v_perm_b32 v138, v79, v78, s88
    v_or_b32 v137, v137, v138
    v_xor_b32 v137, s40, v137
    v_or_b32 v136, v136, v137
    s_waitcnt vmcnt(13)
    v_perm_b32 v137, v81, v80, s43
    v_perm_b32 v138, v83, v82, s88
    v_or_b32 v137, v137, v138
    v_xor_b32 v137, s40, v137
    v_or_b32 v136, v136, v137
    s_waitcnt vmcnt(12)
    v_perm_b32 v137, v85, v84, s43
    v_perm_b32 v138, v87, v86, s88
    v_or_b32 v137, v137, v138
    v_xor_b32 v137, s40, v137
    v_or_b32 v136, v136, v137
    s_waitcnt vmcnt(11)
    v_perm_b32 v137, v89, v88, s43
    v_perm_b32 v138, v91, v90, s88
    v_or_b32 v137, v137, v138
    v_xor_b32 v137, s40, v137
    v_or_b32 v136, v136, v137
    s_waitcnt vmcnt(10)
    v_perm_b32 v137, v93, v92, s43
    v_perm_b32 v138, v95, v94, s88
    v_or_b32 v137, v137, v138
    v_xor_b32 v137, s40, v137
    v_or_b32 v136, v136, v137
    s_waitcnt vmcnt(9)
    v_perm_b32 v137, v97, v96, s43
    v_perm_b32 v138, v99, v98, s88
    v_or_b32 v137, v137, v138
    v_xor_b32 v137, s40, v137
    v_or_b32 v136, v136, v137
    s_waitcnt vmcnt(8)
    v_perm_b32 v137, v101, v100, s43
    v_perm_b32 v138, v103, v102, s88
    v_or_b32 v137, v137, v138
    v_xor_b32 v137, s40, v137
    v_or_b32 v136, v136, v137
    s_waitcnt vmcnt(7)
    v_perm_b32 v137, v105, v104, s43
    v_perm_b32 v138, v107, v106, s88
    v_or_b32 v137, v137, v138
    v_xor_b32 v137, s40, v137
    v_or_b32 v136, v136, v137
    s_waitcnt vmcnt(6)
    v_perm_b32 v137, v109, v108, s43
    v_perm_b32 v138, v111, v110, s88
    v_or_b32 v137, v137, v138
    v_xor_b32 v137, s40, v137
    v_or_b32 v136, v136, v137
    s_waitcnt vmcnt(5)
    v_perm_b32 v137, v113, v112, s43
    v_perm_b32 v138, v115, v114, s88
    v_or_b32 v137, v137, v138
    v_xor_b32 v137, s40, v137
    v_or_b32 v136, v136, v137
    s_waitcnt vmcnt(4)
    v_perm_b32 v137, v117, v116, s43
    v_perm_b32 v138, v119, v118, s88
    v_or_b32 v137, v137, v138
    v_xor_b32 v137, s40, v137
    v_or_b32 v136, v136, v137
    s_waitcnt vmcnt(3)
    v_perm_b32 v137, v121, v120, s43
    v_perm_b32 v138, v123, v122, s88
    v_or_b32 v137, v137, v138
    v_xor_b32 v137, s40, v137
    v_or_b32 v136, v136, v137
    s_waitcnt vmcnt(2)
    v_perm_b32 v137, v125, v124, s43
    v_perm_b32 v138, v127, v126, s88
    v_or_b32 v137, v137, v138
    v_xor_b32 v137, s40, v137
    v_or_b32 v136, v136, v137
    s_waitcnt vmcnt(1)
    v_perm_b32 v137, v129, v128, s43
    v_perm_b32 v138, v131, v130, s88
    v_or_b32 v137, v137, v138
    v_xor_b32 v137, s40, v137
    v_or_b32 v136, v136, v137
    s_waitcnt vmcnt(0)
    v_perm_b32 v137, v133, v132, s43
    v_perm_b32 v138, v135, v134, s88
    v_or_b32 v137, v137, v138
    v_xor_b32 v137, s40, v137
    v_or_b32 v136, v136, v137
    v_cmp_ne_u32 vcc, 0, v136
    s_nop 3
    s_cmp_eq_u64 vcc, 0
    s_cbranch_scc1 L_grd_22
    s_sleep 2
    s_sub_u32 s41, s41, 1
    s_cmp_lg_u32 s41, 0
    s_cbranch_scc1 L_gr_21
L_grd_22:
    v_add_f32 v8, v8, v24
    v_add_f32 v9, v9, v25
    v_add_f32 v10, v10, v26
    v_add_f32 v11, v11, v27
    v_add_f32 v12, v12, v28
    v_add_f32 v13, v13, v29
    v_add_f32 v14, v14, v30
    v_add_f32 v15, v15, v31
    v_add_f32 v16, v16, v32
    v_add_f32 v17, v17, v33
    v_add_f32 v18, v18, v34
    v_add_f32 v19, v19, v35
    v_add_f32 v20, v20, v36
    v_add_f32 v21, v21, v37
    v_add_f32 v22, v22, v38
    v_add_f32 v23, v23, v39
    v_add_f32 v8, v8, v40
    v_add_f32 v9, v9, v41
    v_add_f32 v10, v10, v42
    v_add_f32 v11, v11, v43
    v_add_f32 v12, v12, v44
    v_add_f32 v13, v13, v45
    v_add_f32 v14, v14, v46
    v_add_f32 v15, v15, v47
    v_add_f32 v16, v16, v48
    v_add_f32 v17, v17, v49
    v_add_f32 v18, v18, v50
    v_add_f32 v19, v19, v51
    v_add_f32 v20, v20, v52
    v_add_f32 v21, v21, v53
    v_add_f32 v22, v22, v54
    v_add_f32 v23, v23, v55
    v_add_f32 v8, v8, v56
    v_add_f32 v9, v9, v57
    v_add_f32 v10, v10, v58
    v_add_f32 v11, v11, v59
    v_add_f32 v12, v12, v60
    v_add_f32 v13, v13, v61
    v_add_f32 v14, v14, v62
    v_add_f32 v15, v15, v63
    v_add_f32 v16, v16, v64
    v_add_f32 v17, v17, v65
    v_add_f32 v18, v18, v66
    v_add_f32 v19, v19, v67
    v_add_f32 v20, v20, v68
    v_add_f32 v21, v21, v69
    v_add_f32 v22, v22, v70
    v_add_f32 v23, v23, v71
    v_add_f32 v8, v8, v72
    v_add_f32 v9, v9, v73
    v_add_f32 v10, v10, v74
    v_add_f32 v11, v11, v75
    v_add_f32 v12, v12, v76
    v_add_f32 v13, v13, v77
    v_add_f32 v14, v14, v78
    v_add_f32 v15, v15, v79
    v_add_f32 v16, v16, v80
    v_add_f32 v17, v17, v81
    v_add_f32 v18, v18, v82
    v_add_f32 v19, v19, v83
    v_add_f32 v20, v20, v84
    v_add_f32 v21, v21, v85
    v_add_f32 v22, v22, v86
    v_add_f32 v23, v23, v87
    v_add_f32 v8, v8, v88
    v_add_f32 v9, v9, v89
    v_add_f32 v10, v10, v90
    v_add_f32 v11, v11, v91
    v_add_f32 v12, v12, v92
    v_add_f32 v13, v13, v93
    v_add_f32 v14, v14, v94
    v_add_f32 v15, v15, v95
    v_add_f32 v16, v16, v96
    v_add_f32 v17, v17, v97
    v_add_f32 v18, v18, v98
    v_add_f32 v19, v19, v99
    v_add_f32 v20, v20, v100
    v_add_f32 v21, v21, v101
    v_add_f32 v22, v22, v102
    v_add_f32 v23, v23, v103
    v_add_f32 v8, v8, v104
    v_add_f32 v9, v9, v105
    v_add_f32 v10, v10, v106
    v_add_f32 v11, v11, v107
    v_add_f32 v12, v12, v108
    v_add_f32 v13, v13, v109
    v_add_f32 v14, v14, v110
    v_add_f32 v15, v15, v111
    v_add_f32 v16, v16, v112
    v_add_f32 v17, v17, v113
    v_add_f32 v18, v18, v114
    v_add_f32 v19, v19, v115
    v_add_f32 v20, v20, v116
    v_add_f32 v21, v21, v117
    v_add_f32 v22, v22, v118
    v_add_f32 v23, v23, v119
    v_add_f32 v8, v8, v120
    v_add_f32 v9, v9, v121
    v_add_f32 v10, v10, v122
    v_add_f32 v11, v11, v123
    v_add_f32 v12, v12, v124
    v_add_f32 v13, v13, v125
    v_add_f32 v14, v14, v126
    v_add_f32 v15, v15, v127
    v_add_f32 v16, v16, v128
    v_add_f32 v17, v17, v129
    v_add_f32 v18, v18, v130
    v_add_f32 v19, v19, v131
    v_add_f32 v20, v20, v132
    v_add_f32 v21, v21, v133
    v_add_f32 v22, v22, v134
    v_add_f32 v23, v23, v135
    v_cvt_pk_bf16_f32 v24, v8, v9
    v_cvt_pk_bf16_f32 v25, v10, v11
    v_cvt_pk_bf16_f32 v26, v12, v13
    v_cvt_pk_bf16_f32 v27, v14, v15
    v_cvt_pk_bf16_f32 v28, v16, v17
    v_cvt_pk_bf16_f32 v29, v18, v19
    v_cvt_pk_bf16_f32 v30, v20, v21
    v_cvt_pk_bf16_f32 v31, v22, v23
    v_lshrrev_b32 v2, 5, v0
    v_lshlrev_b32 v2, 8, v2
    v_and_b32 v3, 15, v0
    v_lshl_add_u32 v2, v3, 4, v2
    v_bfe_u32 v3, v0, 4, 1
    v_lshl_add_u32 v2, v3, 3, v2
    ds_write_b64 v2, v[24:25] offset:1024
    ds_write_b64 v2, v[26:27] offset:1536
    ds_write_b64 v2, v[28:29] offset:2048
    ds_write_b64 v2, v[30:31] offset:2560
    s_mov_b64 exec, 1
    v_mov_b32 v2, 0
    v_mov_b32 v3, 1
    ds_add_u32 v2, v3 offset:0
    s_mov_b64 exec, -1
    s_cmp_lt_u32 s2, 128
    s_cbranch_scc1 L_final
    s_endpgm
L_final:
    s_and_b32 s8, s2, 7
    s_lshr_b32 s9, s2, 3
    s_and_b32 s9, s9, 3
    s_lshr_b32 s10, s2, 5
    s_mov_b32 s41, 400000
    v_mov_b32 v3, 0
L_lw_23:
    ds_read_b32 v2, v3 offset:20
    s_waitcnt lgkmcnt(0)
    v_readfirstlane_b32 s4, v2
    s_nop 3
    s_cmp_ge_u32 s4, 8
    s_cbranch_scc1 L_lwd_24
    s_sleep 1
    s_sub_u32 s41, s41, 1
    s_cmp_lg_u32 s41, 0
    s_cbranch_scc1 L_lw_23
L_lwd_24:
    v_and_b32 v3, 7, v0
    s_lshl_b32 s11, s10, 3
    v_add_u32 v3, s11, v3
    v_and_b32 v4, 15, v3
    v_lshlrev_b32 v4, 4, v4
    v_lshrrev_b32 v5, 4, v3
    v_lshl_add_u32 v4, v5, 3, v4
    s_lshl_b32 s13, s9, 11
    s_lshl_b32 s14, s8, 8
    s_add_u32 s13, s13, s14
    buffer_load_dwordx2 v[140:141], v4, s[60:63], s13 offen
    v_lshrrev_b32 v2, 3, v0
    v_lshlrev_b32 v2, 11, v2
    v_lshl_add_u32 v2, v3, 4, v2
    s_lshl_b32 s12, s8, 17
    s_lshl_b32 s14, s9, 9
    s_add_u32 s12, s12, s14
    s_add_u32 s12, s12, 8388608
    s_mul_i32 s4, s40, 0x9e3779b1
    s_lshr_b32 s4, s4, 16
    v_mov_b32 v144, s40
    v_lshrrev_b32 v145, 12, v144
    s_lshr_b32 s5, s40, 24
    s_lshl_b32 s6, s4, 8
    s_or_b32 s5, s5, s6
    v_mov_b32 v146, s5
    s_lshr_b32 s4, s4, 4
    v_mov_b32 v147, s4
    v_and_b32 v36, 0xfff, v144
    v_and_b32 v37, 0xfff, v145
    v_and_b32 v38, 0xfff, v146
    v_and_b32 v39, 0xfff, v147
    s_add_u32 s5, s12, 0
    buffer_load_dwordx4 v[8:11], v2, s[56:59], s5 offen
    s_add_u32 s5, s12, 16384
    buffer_load_dwordx4 v[12:15], v2, s[56:59], s5 offen
    s_add_u32 s5, s12, 32768
    buffer_load_dwordx4 v[16:19], v2, s[56:59], s5 offen
    s_add_u32 s5, s12, 49152
    buffer_load_dwordx4 v[20:23], v2, s[56:59], s5 offen
    s_add_u32 s5, s12, 65536
    buffer_load_dwordx4 v[24:27], v2, s[56:59], s5 offen
    s_add_u32 s5, s12, 81920
    buffer_load_dwordx4 v[28:31], v2, s[56:59], s5 offen
    s_add_u32 s5, s12, 98304
    buffer_load_dwordx4 v[32:35], v2, s[56:59], s5 offen
    s_mov_b32 exec_lo, -1
    s_mov_b32 exec_hi, 0
    s_add_u32 s5, s12, 114688
    buffer_load_dwordx4 v[36:39], v2, s[56:59], s5 offen
    s_mov_b64 exec, -1
    s_waitcnt vmcnt(7)
    v_xor_b32 v137, v8, v144
    v_and_b32 v136, s89, v137
    v_xor_b32 v137, v9, v145
    v_and_or_b32 v136, v137, s89, v136
    v_xor_b32 v137, v10, v146
    v_and_or_b32 v136, v137, s89, v136
    v_xor_b32 v137, v11, v147
    v_and_or_b32 v136, v137, s89, v136
    s_waitcnt vmcnt(6)
    v_xor_b32 v137, v12, v144
    v_and_or_b32 v136, v137, s89, v136
    v_xor_b32 v137, v13, v145
    v_and_or_b32 v136, v137, s89, v136
    v_xor_b32 v137, v14, v146
    v_and_or_b32 v136, v137, s89, v136
    v_xor_b32 v137, v15, v147
    v_and_or_b32 v136, v137, s89, v136
    s_waitcnt vmcnt(5)
    v_xor_b32 v137, v16, v144
    v_and_or_b32 v136, v137, s89, v136
    v_xor_b32 v137, v17, v145
    v_and_or_b32 v136, v137, s89, v136
    v_xor_b32 v137, v18, v146
    v_and_or_b32 v136, v137, s89, v136
    v_xor_b32 v137, v19, v147
    v_and_or_b32 v136, v137, s89, v136
    s_waitcnt vmcnt(4)
    v_xor_b32 v137, v20, v144
    v_and_or_b32 v136, v137, s89, v136
    v_xor_b32 v137, v21, v145
    v_and_or_b32 v136, v137, s89, v136
    v_xor_b32 v137, v22, v146
    v_and_or_b32 v136, v137, s89, v136
    v_xor_b32 v137, v23, v147
    v_and_or_b32 v136, v137, s89, v136
    s_waitcnt vmcnt(3)
    v_xor_b32 v137, v24, v144
    v_and_or_b32 v136, v137, s89, v136
    v_xor_b32 v137, v25, v145
    v_and_or_b32 v136, v137, s89, v136
    v_xor_b32 v137, v26, v146
    v_and_or_b32 v136, v137, s89, v136
    v_xor_b32 v137, v27, v147
    v_and_or_b32 v136, v137, s89, v136
    s_waitcnt vmcnt(2)
    v_xor_b32 v137, v28, v144
    v_and_or_b32 v136, v137, s89, v136
    v_xor_b32 v137, v29, v145
    v_and_or_b32 v136, v137, s89, v136
    v_xor_b32 v137, v30, v146
    v_and_or_b32 v136, v137, s89, v136
    v_xor_b32 v137, v31, v147
    v_and_or_b32 v136, v137, s89, v136
    s_waitcnt vmcnt(1)
    v_xor_b32 v137, v32, v144
    v_and_or_b32 v136, v137, s89, v136
    v_xor_b32 v137, v33, v145
    v_and_or_b32 v136, v137, s89, v136
    v_xor_b32 v137, v34, v146
    v_and_or_b32 v136, v137, s89, v136
    v_xor_b32 v137, v35, v147
    v_and_or_b32 v136, v137, s89, v136
    s_waitcnt vmcnt(0)
    v_xor_b32 v137, v36, v144
    v_and_or_b32 v136, v137, s89, v136
    v_xor_b32 v137, v37, v145
    v_and_or_b32 v136, v137, s89, v136
    v_xor_b32 v137, v38, v146
    v_and_or_b32 v136, v137, s89, v136
    v_xor_b32 v137, v39, v147
    v_and_or_b32 v136, v137, s89, v136
    v_cmp_ne_u32 vcc, 0, v136
    s_nop 3
    s_cmp_eq_u64 vcc, 0
    s_cbranch_scc1 L_grd_26
    s_mov_b32 s41, 100000
L_gr_25:
    v_and_b32 v36, 0xfff, v144
    v_and_b32 v37, 0xfff, v145
    v_and_b32 v38, 0xfff, v146
    v_and_b32 v39, 0xfff, v147
    s_add_u32 s5, s12, 0
    buffer_load_dwordx4 v[8:11], v2, s[56:59], s5 offen sc1
    s_add_u32 s5, s12, 16384
    buffer_load_dwordx4 v[12:15], v2, s[56:59], s5 offen sc1
    s_add_u32 s5, s12, 32768
    buffer_load_dwordx4 v[16:19], v2, s[56:59], s5 offen sc1
    s_add_u32 s5, s12, 49152
    buffer_load_dwordx4 v[20:23], v2, s[56:59], s5 offen sc1
    s_add_u32 s5, s12, 65536
    buffer_load_dwordx4 v[24:27], v2, s[56:59], s5 offen sc1
    s_add_u32 s5, s12, 81920
    buffer_load_dwordx4 v[28:31], v2, s[56:59], s5 offen sc1
    s_add_u32 s5, s12, 98304
    buffer_load_dwordx4 v[32:35], v2, s[56:59], s5 offen sc1
    s_mov_b32 exec_lo, -1
    s_mov_b32 exec_hi, 0
    s_add_u32 s5, s12, 114688
    buffer_load_dwordx4 v[36:39], v2, s[56:59], s5 offen sc1
    s_mov_b64 exec, -1
    s_waitcnt vmcnt(7)
    v_xor_b32 v137, v8, v144
    v_and_b32 v136, s89, v137
    v_xor_b32 v137, v9, v145
    v_and_or_b32 v136, v137, s89, v136
    v_xor_b32 v137, v10, v146
    v_and_or_b32 v136, v137, s89, v136
    v_xor_b32 v137, v11, v147
    v_and_or_b32 v136, v137, s89, v136
    s_waitcnt vmcnt(6)
    v_xor_b32 v137, v12, v144
    v_and_or_b32 v136, v137, s89, v136
    v_xor_b32 v137, v13, v145
    v_and_or_b32 v136, v137, s89, v136
    v_xor_b32 v137, v14, v146
    v_and_or_b32 v136, v137, s89, v136
    v_xor_b32 v137, v15, v147
    v_and_or_b32 v136, v137, s89, v136
    s_waitcnt vmcnt(5)
    v_xor_b32 v137, v16, v144
    v_and_or_b32 v136, v137, s89, v136
    v_xor_b32 v137, v17, v145
    v_and_or_b32 v136, v137, s89, v136
    v_xor_b32 v137, v18, v146
    v_and_or_b32 v136, v137, s89, v136
    v_xor_b32 v137, v19, v147
    v_and_or_b32 v136, v137, s89, v136
    s_waitcnt vmcnt(4)
    v_xor_b32 v137, v20, v144
    v_and_or_b32 v136, v137, s89, v136
    v_xor_b32 v137, v21, v145
    v_and_or_b32 v136, v137, s89, v136
    v_xor_b32 v137, v22, v146
    v_and_or_b32 v136, v137, s89, v136
    v_xor_b32 v137, v23, v147
    v_and_or_b32 v136, v137, s89, v136
    s_waitcnt vmcnt(3)
    v_xor_b32 v137, v24, v144
    v_and_or_b32 v136, v137, s89, v136
    v_xor_b32 v137, v25, v145
    v_and_or_b32 v136, v137, s89, v136
    v_xor_b32 v137, v26, v146
    v_and_or_b32 v136, v137, s89, v136
    v_xor_b32 v137, v27, v147
    v_and_or_b32 v136, v137, s89, v136
    s_waitcnt vmcnt(2)
    v_xor_b32 v137, v28, v144
    v_and_or_b32 v136, v137, s89, v136
    v_xor_b32 v137, v29, v145
    v_and_or_b32 v136, v137, s89, v136
    v_xor_b32 v137, v30, v146
    v_and_or_b32 v136, v137, s89, v136
    v_xor_b32 v137, v31, v147
    v_and_or_b32 v136, v137, s89, v136
    s_waitcnt vmcnt(1)
    v_xor_b32 v137, v32, v144
    v_and_or_b32 v136, v137, s89, v136
    v_xor_b32 v137, v33, v145
    v_and_or_b32 v136, v137, s89, v136
    v_xor_b32 v137, v34, v146
    v_and_or_b32 v136, v137, s89, v136
    v_xor_b32 v137, v35, v147
    v_and_or_b32 v136, v137, s89, v136
    s_waitcnt vmcnt(0)
    v_xor_b32 v137, v36, v144
    v_and_or_b32 v136, v137, s89, v136
    v_xor_b32 v137, v37, v145
    v_and_or_b32 v136, v137, s89, v136
    v_xor_b32 v137, v38, v146
    v_and_or_b32 v136, v137, s89, v136
    v_xor_b32 v137, v39, v147
    v_and_or_b32 v136, v137, s89, v136
    v_cmp_ne_u32 vcc, 0, v136
    s_nop 3
    s_cmp_eq_u64 vcc, 0
    s_cbranch_scc1 L_grd_26
    s_sleep 2
    s_sub_u32 s41, s41, 1
    s_cmp_lg_u32 s41, 0
    s_cbranch_scc1 L_gr_25
L_grd_26:
    v_add_f32 v8, v8, v12
    v_add_f32 v16, v16, v20
    v_add_f32 v24, v24, v28
    v_add_f32 v32, v32, v36
    v_add_f32 v9, v9, v13
    v_add_f32 v17, v17, v21
    v_add_f32 v25, v25, v29
    v_add_f32 v33, v33, v37
    v_add_f32 v10, v10, v14
    v_add_f32 v18, v18, v22
    v_add_f32 v26, v26, v30
    v_add_f32 v34, v34, v38
    v_add_f32 v11, v11, v15
    v_add_f32 v19, v19, v23
    v_add_f32 v27, v27, v31
    v_add_f32 v35, v35, v39
    v_add_f32 v8, v8, v16
    v_add_f32 v12, v24, v32
    v_add_f32 v9, v9, v17
    v_add_f32 v13, v25, v33
    v_add_f32 v10, v10, v18
    v_add_f32 v14, v26, v34
    v_add_f32 v11, v11, v19
    v_add_f32 v15, v27, v35
    s_nop 1
    v_add_f32_dpp v8, v8, v8 row_ror:8 row_mask:0xf bank_mask:0xf
    v_add_f32_dpp v9, v9, v9 row_ror:8 row_mask:0xf bank_mask:0xf
    v_add_f32_dpp v10, v10, v10 row_ror:8 row_mask:0xf bank_mask:0xf
    v_add_f32_dpp v11, v11, v11 row_ror:8 row_mask:0xf bank_mask:0xf
    v_add_f32_dpp v12, v12, v12 row_ror:8 row_mask:0xf bank_mask:0xf
    v_add_f32_dpp v13, v13, v13 row_ror:8 row_mask:0xf bank_mask:0xf
    v_add_f32_dpp v14, v14, v14 row_ror:8 row_mask:0xf bank_mask:0xf
    v_add_f32_dpp v15, v15, v15 row_ror:8 row_mask:0xf bank_mask:0xf
    v_mov_b32 v40, v8
    v_mov_b32 v41, v9
    v_mov_b32 v42, v10
    v_mov_b32 v43, v11
    v_mov_b32 v44, v12
    v_mov_b32 v45, v13
    v_mov_b32 v46, v14
    v_mov_b32 v47, v15
    s_nop 1
    v_permlane32_swap_b32 v8, v40
    v_permlane32_swap_b32 v9, v41
    v_permlane32_swap_b32 v10, v42
    v_permlane32_swap_b32 v11, v43
    v_permlane32_swap_b32 v12, v44
    v_permlane32_swap_b32 v13, v45
    v_permlane32_swap_b32 v14, v46
    v_permlane32_swap_b32 v15, v47
    s_nop 1
    v_add_f32 v8, v8, v40
    v_add_f32 v9, v9, v41
    v_add_f32 v10, v10, v42
    v_add_f32 v11, v11, v43
    v_add_f32 v12, v12, v44
    v_add_f32 v13, v13, v45
    v_add_f32 v14, v14, v46
    v_add_f32 v15, v15, v47
    v_mov_b32 v40, v8
    v_mov_b32 v41, v9
    v_mov_b32 v42, v10
    v_mov_b32 v43, v11
    v_mov_b32 v44, v12
    v_mov_b32 v45, v13
    v_mov_b32 v46, v14
    v_mov_b32 v47, v15
    s_nop 1
    v_permlane16_swap_b32 v8, v40
    v_permlane16_swap_b32 v9, v41
    v_permlane16_swap_b32 v10, v42
    v_permlane16_swap_b32 v11, v43
    v_permlane16_swap_b32 v12, v44
    v_permlane16_swap_b32 v13, v45
    v_permlane16_swap_b32 v14, v46
    v_permlane16_swap_b32 v15, v47
    s_nop 1
    v_add_f32 v8, v8, v40
    v_add_f32 v9, v9, v41
    v_add_f32 v10, v10, v42
    v_add_f32 v11, v11, v43
    v_add_f32 v12, v12, v44
    v_add_f32 v13, v13, v45
    v_add_f32 v14, v14, v46
    v_add_f32 v15, v15, v47
    s_mov_b32 s14, 0xbfb8aa3b
    v_cvt_pk_bf16_f32 v8, v8, v8
    v_lshlrev_b32 v8, 16, v8
    v_cvt_pk_bf16_f32 v12, v12, v12
    v_lshlrev_b32 v12, 16, v12
    v_mul_f32 v16, s14, v12
    v_exp_f32 v16, v16
    s_nop 0
    v_add_f32 v16, 1.0, v16
    v_rcp_f32 v16, v16
    s_nop 0
    v_mul_f32 v16, v16, v12
    v_cvt_pk_bf16_f32 v16, v16, v16
    v_lshlrev_b32 v16, 16, v16
    v_mul_f32 v16, v16, v8
    v_cvt_pk_bf16_f32 v16, v16, v16
    v_lshlrev_b32 v16, 16, v16
    v_lshlrev_b32 v8, 16, v140
    v_add_f32 v16, v16, v8
    v_cvt_pk_bf16_f32 v9, v9, v9
    v_lshlrev_b32 v9, 16, v9
    v_cvt_pk_bf16_f32 v13, v13, v13
    v_lshlrev_b32 v13, 16, v13
    v_mul_f32 v17, s14, v13
    v_exp_f32 v17, v17
    s_nop 0
    v_add_f32 v17, 1.0, v17
    v_rcp_f32 v17, v17
    s_nop 0
    v_mul_f32 v17, v17, v13
    v_cvt_pk_bf16_f32 v17, v17, v17
    v_lshlrev_b32 v17, 16, v17
    v_mul_f32 v17, v17, v9
    v_cvt_pk_bf16_f32 v17, v17, v17
    v_lshlrev_b32 v17, 16, v17
    v_and_b32 v9, 0xffff0000, v140
    v_add_f32 v17, v17, v9
    v_cvt_pk_bf16_f32 v10, v10, v10
    v_lshlrev_b32 v10, 16, v10
    v_cvt_pk_bf16_f32 v14, v14, v14
    v_lshlrev_b32 v14, 16, v14
    v_mul_f32 v18, s14, v14
    v_exp_f32 v18, v18
    s_nop 0
    v_add_f32 v18, 1.0, v18
    v_rcp_f32 v18, v18
    s_nop 0
    v_mul_f32 v18, v18, v14
    v_cvt_pk_bf16_f32 v18, v18, v18
    v_lshlrev_b32 v18, 16, v18
    v_mul_f32 v18, v18, v10
    v_cvt_pk_bf16_f32 v18, v18, v18
    v_lshlrev_b32 v18, 16, v18
    v_lshlrev_b32 v10, 16, v141
    v_add_f32 v18, v18, v10
    v_cvt_pk_bf16_f32 v11, v11, v11
    v_lshlrev_b32 v11, 16, v11
    v_cvt_pk_bf16_f32 v15, v15, v15
    v_lshlrev_b32 v15, 16, v15
    v_mul_f32 v19, s14, v15
    v_exp_f32 v19, v19
    s_nop 0
    v_add_f32 v19, 1.0, v19
    v_rcp_f32 v19, v19
    s_nop 0
    v_mul_f32 v19, v19, v15
    v_cvt_pk_bf16_f32 v19, v19, v19
    v_lshlrev_b32 v19, 16, v19
    v_mul_f32 v19, v19, v11
    v_cvt_pk_bf16_f32 v19, v19, v19
    v_lshlrev_b32 v19, 16, v19
    v_and_b32 v11, 0xffff0000, v141
    v_add_f32 v19, v19, v11
    v_cvt_pk_bf16_f32 v20, v16, v17
    v_cvt_pk_bf16_f32 v21, v18, v19
    s_mov_b64 exec, 0xff
    buffer_store_dwordx2 v[20:21], v4, s[64:67], s13 offen
    s_mov_b64 exec, -1
    s_cmp_lg_u32 s2, 0
    s_cbranch_scc1 L_end
    s_mov_b64 exec, 1
    v_mov_b32 v2, 0
    v_mov_b32 v3, s40
    buffer_store_dword v3, v2, s[56:59], 0 offen sc1
L_end:
    s_endpgm
.section .rodata,"a"
.p2align 6
.amdhsa_kernel recurrent_scan__gqa_block_cached__glu_gated_geglu__decode_kernel
  .amdhsa_next_free_vgpr 168
  .amdhsa_next_free_sgpr 100
  .amdhsa_accum_offset 168
  .amdhsa_group_segment_fixed_size 0
  .amdhsa_kernarg_size 96
  .amdhsa_user_sgpr_count 2
  .amdhsa_user_sgpr_kernarg_segment_ptr 1
  .amdhsa_system_sgpr_workgroup_id_x 1
.end_amdhsa_kernel
```
